```python
import torch

def _softmax(x, axis=-1):
    return torch.softmax(x, dim=axis)
def _gelu(x):
    return torch.nn.functional.gelu(x, approximate="tanh")
def _silu(x):
    return torch.nn.functional.silu(x)
def _sigmoid(x):
    return torch.sigmoid(x)
def _layernorm(x, axis=-1, eps=1e-5):
    m = x.mean(dim=axis, keepdim=True)
    v = x.var(dim=axis, keepdim=True, unbiased=False)
    return (x - m) / torch.sqrt(v + eps)
def _scatter_add(tgt, idx, src, axis=0):
    return tgt.clone().index_add_(axis, idx, src)
def _segment_sum(src, seg, n):
    out = torch.zeros((n,) + src.shape[1:], dtype=src.dtype)
    return out.index_add_(0, seg, src)
def _pad(x, pw):
    flat = tuple(v for pair in reversed(pw) for v in pair)
    return torch.nn.functional.pad(x, flat)

kernel_name = 'recurrent_scan__ssm_conv_s5__glu_gated_bilinear__prompt'

def setup_inputs():

    _w = (lambda a: (lambda t: t.to(torch.bfloat16) if t.is_floating_point() else t)(torch.as_tensor(a)))
    def _A_setup():
        B, S, D = 1, 2048, 448
        P = D
        Lambda_re = -0.5 * (lambda _x: torch.exp(torch.as_tensor(_x)))((lambda *s: torch.randn(*s, dtype=torch.bfloat16) * 0.8)(P))
        Lambda_im = (lambda *s: torch.randn(*s, dtype=torch.bfloat16) * 0.8)(P) * 1.0
        B_re = (lambda *s: torch.randn(*s, dtype=torch.bfloat16) * 1.6)(P, D) * (D ** -0.5)
        B_im = (lambda *s: torch.randn(*s, dtype=torch.bfloat16) * 1.6)(P, D) * (D ** -0.5)
        C_re = (lambda *s: torch.randn(*s, dtype=torch.bfloat16) * 1.6)(D, P) * (P ** -0.5)
        C_im = (lambda *s: torch.randn(*s, dtype=torch.bfloat16) * 1.6)(D, P) * (P ** -0.5)
        log_dt = (lambda *s: torch.randn(*s, dtype=torch.bfloat16) * 0.8)(P) * 0.3 - 2.0
        Dskip = (lambda *s: torch.randn(*s, dtype=torch.bfloat16) * 0.8)(D)
        return {
            "x": _w((lambda *s: torch.randn(*s, dtype=torch.bfloat16) * 0.05)(B, S, D)),
            "Lambda_re": _w(Lambda_re),
            "Lambda_im": _w(Lambda_im),
            "B_re": _w(B_re),
            "B_im": _w(B_im),
            "C_re": _w(C_re),
            "C_im": _w(C_im),
            "log_dt": _w(log_dt),
            "Dskip": _w(Dskip),
        }
    _A_in = _A_setup()

    def _B_setup():
        B, S, D, F = 1, 2048, 448, 1792
        return {
            "x": _w((lambda *s: torch.randn(*s, dtype=torch.bfloat16) * 0.05)(B, S, D)),
            "w_gate": _w((lambda *s: torch.randn(*s, dtype=torch.bfloat16) * 0.2)(D, F) * (D ** -0.5)),
            "w_up": _w((lambda *s: torch.randn(*s, dtype=torch.bfloat16) * 0.2)(D, F) * (D ** -0.5)),
            "w_down": _w((lambda *s: torch.randn(*s, dtype=torch.bfloat16) * 0.2)(F, D) * (F ** -0.5)),
        }
    _B_in = _B_setup()

    return {
        "A_x": _A_in["x"],
        "A_Lambda_re": _A_in["Lambda_re"],
        "A_Lambda_im": _A_in["Lambda_im"],
        "A_B_re": _A_in["B_re"],
        "A_B_im": _A_in["B_im"],
        "A_C_re": _A_in["C_re"],
        "A_C_im": _A_in["C_im"],
        "A_log_dt": _A_in["log_dt"],
        "A_Dskip": _A_in["Dskip"],
        "B_x": _B_in["x"],
        "B_w_gate": _B_in["w_gate"],
        "B_w_up": _B_in["w_up"],
        "B_w_down": _B_in["w_down"],
    }

def reference(A_x, A_Lambda_re, A_Lambda_im, A_B_re, A_B_im, A_C_re, A_C_im, A_log_dt, A_Dskip, B_x, B_w_gate, B_w_up, B_w_down):
    def _A_ref(x, Lambda_re, Lambda_im, B_re, B_im, C_re, C_im, log_dt, Dskip):
        Bsz, L, H = x.shape
        Lam = Lambda_re + 1j * Lambda_im
        Bmat = B_re + 1j * B_im
        Cmat = C_re + 1j * C_im
        dt = torch.exp(log_dt)
        Lam_bar = torch.exp(dt * Lam)
        B_bar = ((Lam_bar - 1.0) / Lam)[:, None] * Bmat
        Bu = torch.einsum("bld,pd->blp", x + 0j, B_bar)
        h = torch.zeros_like(Bu[:, 0, :])
        hs = []
        for t in range(L):
            h = Lam_bar[None, :] * h + Bu[:, t, :]
            hs.append(h)
        hseq = torch.stack(hs, 1)
        y = 2.0 * torch.einsum("blp,dp->bld", hseq, Cmat).real + x * Dskip[None, None, :]
        return y

    def _B_ref(x, w_gate, w_up, w_down):
        g = torch.einsum("bsd,df->bsf", x, w_gate)
        u = torch.einsum("bsd,df->bsf", x, w_up)
        h = g * u
        return torch.einsum("bsf,fd->bsd", h, w_down)

    x = A_x
    xn = _layernorm(x, axis=-1)
    s = _A_ref(xn, A_Lambda_re, A_Lambda_im, A_B_re, A_B_im, A_C_re, A_C_im, A_log_dt, A_Dskip)
    g = _silu(_B_ref(xn, B_w_gate, B_w_up, B_w_down))
    return x + s * g
```

```asm
; @launch grid=(256,1,1) block=(256,1,1) lds=163840
.amdgcn_target "amdgcn-amd-amdhsa--gfx950"
.text
.globl recurrent_scan__ssm_conv_s5__glu_gated_bilinear__prompt_kernel
.p2align 8
.type recurrent_scan__ssm_conv_s5__glu_gated_bilinear__prompt_kernel,@function
recurrent_scan__ssm_conv_s5__glu_gated_bilinear__prompt_kernel:
  s_load_dwordx2 s[8:9], s[0:1], 0
  s_cmp_lt_u32 s2, 32
  s_cbranch_scc0 L_wk
  s_getpc_b64 s[4:5]
L_pc:
  v_lshlrev_b32 v1, 7, v0
  v_min_u32 v1, L_last-L_pc, v1
  global_load_dword v11, v1, s[4:5]
  s_branch L_help
L_wk:
  s_cmp_ge_u32 s2, 256
  s_cbranch_scc1 L_end
  s_load_dwordx16 s[64:79], s[0:1], 0
  s_load_dwordx8 s[80:87], s[0:1], 80
  s_load_dwordx4 s[20:23], s[0:1], 112
  s_load_dwordx2 s[56:57], s[0:1], 64
  s_sub_u32 s2, s2, 32
  v_lshrrev_b32 v161, 6, v0
  v_and_b32_e64 v0, 63, v0
  v_readfirstlane_b32 s3, v161
  s_and_b32 s6, s2, 7
  s_lshr_b32 s7, s2, 3
  s_lshr_b32 s28, s6, 1
  s_lshl_b32 s28, s28, 2
  s_and_b32 s30, s7, 3
  s_add_u32 s28, s28, s30
  s_lshr_b32 s7, s7, 2
  s_and_b32 s29, s6, 1
  s_mul_i32 s29, s29, 7
  s_add_u32 s29, s29, s7
  v_and_b32 v129, 31, v0
  v_lshlrev_b32 v211, 7, v129
  s_lshl_b32 s52, s29, 2
  s_add_u32 s52, s52, s3
  s_lshl_b32 s52, s52, 11
  s_mul_i32 s53, s28, 114688
  s_add_u32 s52, s52, s53
  s_mov_b32 s10, 1835008
  s_mov_b32 s11, 0x20000
  v_lshrrev_b32 v170, 3, v0
  s_movk_i32 s44, 896
  v_mul_u32_u24 v166, s44, v170
  v_lshrrev_b32_e64 v171, 4, v0
  v_and_b32 v167, 7, v0
  v_xor_b32 v171, v171, v167
  v_lshl_add_u32 v162, v171, 4, v166
  v_xor_b32_e64 v163, 64, v162
  v_add_u32 v164, 12288, v162
  v_add_u32 v165, 18432, v163
  v_add_u32 v163, 6144, v163
  s_lshl_b32 s31, s28, 2
  s_add_u32 s31, s31, s3
  s_mul_i32 s40, s31, 28672
  s_mul_i32 s41, s3, 28672
  s_lshl_b32 s42, s29, 6
  v_lshl_add_u32 v173, v129, 1, s42
  s_mov_b64 exec, 0xffff
  s_waitcnt lgkmcnt(0)
  buffer_load_dword a63, v211, s[8:11], s52 offen
  s_mov_b64 exec, -1
  s_add_u32 m0, s41, 0
  s_add_u32 s43, s40, 0
  buffer_load_dwordx4 v162, s[8:11], s43 offen offset:0 lds
  buffer_load_dwordx4 v163, s[8:11], s43 offen offset:1024 lds
  buffer_load_dwordx4 v164, s[8:11], s43 offen offset:2048 lds
  buffer_load_dwordx4 v165, s[8:11], s43 offen offset:3072 lds
  global_load_ushort v176, v173, s[66:67]
  global_load_ushort v177, v173, s[68:69]
  global_load_ushort v178, v173, s[78:79]
  s_add_u32 m0, s41, 4096
  s_add_u32 s43, s40, 128
  buffer_load_dwordx4 v162, s[8:11], s43 offen offset:0 lds
  buffer_load_dwordx4 v163, s[8:11], s43 offen offset:1024 lds
  buffer_load_dwordx4 v164, s[8:11], s43 offen offset:2048 lds
  buffer_load_dwordx4 v165, s[8:11], s43 offen offset:3072 lds
  v_and_b32 v130, 3, v0
  v_lshrrev_b32_e64 v128, 5, v0
  v_bfe_u32 v171, v0, 2, 1
  v_lshlrev_b32_e64 v171, 4, v171
  v_bfe_u32 v175, v0, 3, 2
  v_lshl_add_u32 v171, v175, 2, v171
  v_add_u32_e64 v131, v171, v130
  v_lshlrev_b32 v175, 7, v131
  v_add_u32 v175, s41, v175
  s_add_u32 m0, s41, 8192
  s_add_u32 s43, s40, 256
  buffer_load_dwordx4 v162, s[8:11], s43 offen offset:0 lds
  v_bfe_u32 v179, v131, 1, 3
  v_xor_b32 v179, v179, v128
  v_xor_b32 v192, 0, v179
  v_lshl_add_u32 v188, v192, 4, v175
  v_xor_b32_e64 v192, 2, v179
  v_lshl_add_u32 v189, v192, 4, v175
  v_xor_b32_e64 v192, 4, v179
  v_lshl_add_u32 v190, v192, 4, v175
  v_xor_b32_e64 v192, 6, v179
  buffer_load_dwordx4 v163, s[8:11], s43 offen offset:1024 lds
  v_lshl_add_u32 v191, v192, 4, v175
  v_mov_b32 v136, 0
  v_mov_b32 v137, 0
  v_mov_b32 v138, 0
  v_mov_b32 v139, 0
  s_mov_b32 s44, 0x3f803f80
  s_and_b32 s46, s3, 1
  s_cmp_lt_u32 s3, 2
  s_cselect_b32 s16, s80, s82
  s_cselect_b32 s17, s81, s83
  s_mov_b64 s[12:13], s[70:71]
  buffer_load_dwordx4 v164, s[8:11], s43 offen offset:2048 lds
  s_mov_b64 s[92:93], s[72:73]
  s_mov_b64 s[64:65], s[74:75]
  s_mov_b64 s[96:97], s[76:77]
  s_lshl_b32 s49, s46, 6
  v_xor_b32 v244, s49, v162
  s_mul_i32 s49, s3, 7168
  v_add_u32_e64 v244, s49, v244
  s_mov_b32 s18, 1605632
  s_mov_b32 s19, 0x20000
  buffer_load_dwordx4 v165, s[8:11], s43 offen offset:3072 lds
  s_mul_i32 s45, s3, 7168
  v_lshlrev_b32 v175, 2, v166
  v_lshrrev_b32 v171, 2, v0
  v_and_b32 v171, 4, v171
  v_xor_b32 v171, v171, v167
  v_lshl_add_u32 v14, v171, 4, v175
  v_lshl_add_u32 v224, v171, 4, v166
  s_mul_i32 s48, s46, 200704
  s_lshl_b32 s49, s29, 7
  s_add_u32 m0, s41, 12288
  s_add_u32 s43, s40, 384
  buffer_load_dwordx4 v162, s[8:11], s43 offen offset:0 lds
  s_add_u32 s48, s48, s49
  v_add_u32_e64 v14, s48, v14
  s_mul_i32 s48, s3, 200704
  s_lshl_b32 s49, s7, 7
  s_add_u32 s48, s48, s49
  v_add_u32_e64 v224, s48, v224
  s_mov_b32 s68, s84
  s_mov_b32 s69, s85
  s_mov_b32 s70, 1605632
  buffer_load_dwordx4 v163, s[8:11], s43 offen offset:1024 lds
  s_mov_b32 s71, 0x20000
  s_movk_i32 s39, 6144
  s_add_u32 s81, s45, 86016
  s_mov_b32 s33, 27648
  s_mov_b32 s34, 55296
  s_mov_b32 s35, 82944
  s_mov_b32 s36, 114688
  s_mov_b32 s37, 142336
  s_mov_b32 s38, 169984
  buffer_load_dwordx4 v164, s[8:11], s43 offen offset:2048 lds
  v_bfe_u32 v179, v0, 2, 2
  v_lshlrev_b32 v144, 7, v179
  v_and_b32_e64 v171, 8, v0
  v_lshl_add_u32 v144, v171, 3, v144
  v_and_b32_e64 v171, 16, v0
  v_lshl_add_u32 v144, v171, 1, v144
  v_lshl_add_u32 v144, v130, 3, v144
  v_lshl_add_u32 v12, v128, 10, v144
  v_xor_b32_e64 v13, 64, v12
  buffer_load_dwordx4 v165, s[8:11], s43 offen offset:3072 lds
  v_add_u32 v140, 114688, v12
  v_add_u32 v141, 114688, v13
  s_waitcnt vmcnt(12)
  ds_read_b128 v[16:19], v188 offset:0
  ds_read_b128 v[20:23], v189 offset:0
  ds_read_b128 v[24:27], v190 offset:0
  ds_read_b128 v[28:31], v191 offset:0
  s_add_u32 m0, s41, 16384
  s_add_u32 s43, s40, 512
  buffer_load_dwordx4 v162, s[8:11], s43 offen offset:0 lds
  v_lshlrev_b32 v176, 16, v176
  v_lshlrev_b32 v177, 16, v177
  v_lshlrev_b32 v178, 16, v178
  v_mul_f32 v178, 0x3fb8aa3b, v178
  v_exp_f32 v178, v178
  v_mul_f32 v210, v176, v176
  v_cvt_pk_bf16_f32 v178, v178, v178
  v_and_b32 v178, 0xffff0000, v178
  buffer_load_dwordx4 v163, s[8:11], s43 offen offset:1024 lds
  v_mul_f32 v197, v178, v176
  v_mul_f32 v198, v178, v177
  v_mul_f32 v197, 0x3fb8aa3b, v197
  v_exp_f32_e64 v197, v197
  v_mul_f32 v198, 0x3e22f983, v198
  v_rndne_f32 v199, v198
  v_sub_f32 v198, v198, v199
  v_cos_f32 v199, v198
  buffer_load_dwordx4 v164, s[8:11], s43 offen offset:2048 lds
  v_sin_f32 v204, v198
  v_fmac_f32 v210, v177, v177
  v_mul_f32 v2, v197, v199
  v_mul_f32 v3, v197, v204
  v_rcp_f32 v197, v210
  v_add_f32 v198, -1.0, v2
  v_mul_f32 v199, v198, v176
  v_fmac_f32 v199, v3, v177
  buffer_load_dwordx4 v165, s[8:11], s43 offen offset:3072 lds
  v_mul_f32_e64 v204, v3, v176
  v_fma_f32 v204, -v198, v177, v204
  v_add_f32_e64 v197, v197, v197
  v_mul_f32 v10, v199, v197
  v_mul_f32 v11, v204, v197
  v_mul_f32 v197, v3, v3
  v_mul_f32 v198, v2, v3
  v_fma_f32 v4, v2, v2, -v197
  s_waitcnt vmcnt(12)
  ds_read_b128 v[32:35], v188 offset:4096
  ds_read_b128 v[36:39], v189 offset:4096
  ds_read_b128 v[40:43], v190 offset:4096
  ds_read_b128 v[44:47], v191 offset:4096
  s_waitcnt lgkmcnt(4)
  s_add_u32 m0, s41, 20480
  s_add_u32 s43, s40, 640
  buffer_load_dwordx4 v162, s[8:11], s43 offen offset:0 lds
  v_dot2c_f32_bf16 v136, s44, v16
  v_dot2c_f32_bf16 v138, v16, v16
  v_dot2c_f32_bf16 v137, s44, v17
  v_dot2c_f32_bf16 v139, v17, v17
  v_dot2c_f32_bf16 v136, s44, v18
  v_dot2c_f32_bf16 v138, v18, v18
  v_dot2c_f32_bf16 v137, s44, v19
  v_dot2c_f32_bf16 v139, v19, v19
  v_add_f32 v5, v198, v198
  v_mul_f32 v197, v5, v5
  buffer_load_dwordx4 v163, s[8:11], s43 offen offset:1024 lds
  v_dot2c_f32_bf16 v136, s44, v20
  v_dot2c_f32_bf16 v138, v20, v20
  v_dot2c_f32_bf16 v137, s44, v21
  v_dot2c_f32_bf16 v139, v21, v21
  v_dot2c_f32_bf16 v136, s44, v22
  v_dot2c_f32_bf16 v138, v22, v22
  v_dot2c_f32_bf16 v137, s44, v23
  v_dot2c_f32_bf16 v139, v23, v23
  v_mul_f32_e64 v198, v4, v5
  v_fma_f32 v4, v4, v4, -v197
  buffer_load_dwordx4 v164, s[8:11], s43 offen offset:2048 lds
  v_dot2c_f32_bf16 v136, s44, v24
  v_dot2c_f32_bf16 v138, v24, v24
  v_dot2c_f32_bf16 v137, s44, v25
  v_dot2c_f32_bf16 v139, v25, v25
  v_dot2c_f32_bf16 v136, s44, v26
  v_dot2c_f32_bf16 v138, v26, v26
  v_dot2c_f32_bf16 v137, s44, v27
  v_dot2c_f32_bf16 v139, v27, v27
  v_add_f32 v5, v198, v198
  v_mul_f32 v197, v5, v5
  buffer_load_dwordx4 v165, s[8:11], s43 offen offset:3072 lds
  v_dot2c_f32_bf16 v136, s44, v28
  v_dot2c_f32_bf16 v138, v28, v28
  v_dot2c_f32_bf16 v137, s44, v29
  v_dot2c_f32_bf16 v139, v29, v29
  v_dot2c_f32_bf16 v136, s44, v30
  v_dot2c_f32_bf16 v138, v30, v30
  v_dot2c_f32_bf16 v137, s44, v31
  v_dot2c_f32_bf16 v139, v31, v31
  v_mul_f32_e64 v198, v4, v5
  v_fma_f32 v4, v4, v4, -v197
  s_waitcnt vmcnt(12)
  ds_read_b128 v[48:51], v188 offset:8192
  ds_read_b128 v[52:55], v189 offset:8192
  ds_read_b128 v[56:59], v190 offset:8192
  ds_read_b128 v[60:63], v191 offset:8192
  s_waitcnt lgkmcnt(4)
  s_add_u32 m0, s41, 24576
  s_add_u32 s43, s40, 768
  buffer_load_dwordx4 v162, s[8:11], s43 offen offset:0 lds
  v_dot2c_f32_bf16 v136, s44, v32
  v_dot2c_f32_bf16 v138, v32, v32
  v_dot2c_f32_bf16 v137, s44, v33
  v_dot2c_f32_bf16 v139, v33, v33
  v_dot2c_f32_bf16 v136, s44, v34
  v_dot2c_f32_bf16 v138, v34, v34
  v_dot2c_f32_bf16 v137, s44, v35
  v_dot2c_f32_bf16 v139, v35, v35
  v_add_f32 v5, v198, v198
  v_mul_f32 v197, v5, v5
  buffer_load_dwordx4 v163, s[8:11], s43 offen offset:1024 lds
  v_dot2c_f32_bf16 v136, s44, v36
  v_dot2c_f32_bf16 v138, v36, v36
  v_dot2c_f32_bf16 v137, s44, v37
  v_dot2c_f32_bf16 v139, v37, v37
  v_dot2c_f32_bf16 v136, s44, v38
  v_dot2c_f32_bf16 v138, v38, v38
  v_dot2c_f32_bf16 v137, s44, v39
  v_dot2c_f32_bf16 v139, v39, v39
  v_mul_f32_e64 v198, v4, v5
  v_fma_f32 v4, v4, v4, -v197
  buffer_load_dwordx4 v164, s[8:11], s43 offen offset:2048 lds
  v_dot2c_f32_bf16 v136, s44, v40
  v_dot2c_f32_bf16 v138, v40, v40
  v_dot2c_f32_bf16 v137, s44, v41
  v_dot2c_f32_bf16 v139, v41, v41
  v_dot2c_f32_bf16 v136, s44, v42
  v_dot2c_f32_bf16 v138, v42, v42
  v_dot2c_f32_bf16 v137, s44, v43
  v_dot2c_f32_bf16 v139, v43, v43
  v_add_f32 v5, v198, v198
  v_mul_f32 v197, v5, v5
  buffer_load_dwordx4 v165, s[8:11], s43 offen offset:3072 lds
  v_dot2c_f32_bf16 v136, s44, v44
  v_dot2c_f32_bf16 v138, v44, v44
  v_dot2c_f32_bf16 v137, s44, v45
  v_dot2c_f32_bf16 v139, v45, v45
  v_dot2c_f32_bf16 v136, s44, v46
  v_dot2c_f32_bf16 v138, v46, v46
  v_dot2c_f32_bf16 v137, s44, v47
  v_dot2c_f32_bf16 v139, v47, v47
  v_mul_f32_e64 v198, v4, v5
  v_fma_f32 v6, v4, v4, -v197
  s_waitcnt vmcnt(12)
  ds_read_b128 v[64:67], v188 offset:12288
  ds_read_b128 v[68:71], v189 offset:12288
  ds_read_b128 v[72:75], v190 offset:12288
  ds_read_b128 v[76:79], v191 offset:12288
  s_waitcnt lgkmcnt(4)
  s_add_u32 m0, s45, 114688
  s_nop 0
  buffer_load_dwordx4 v14, s[16:19], 0 offen offset:0 lds
  v_dot2c_f32_bf16 v136, s44, v48
  v_dot2c_f32_bf16 v138, v48, v48
  v_dot2c_f32_bf16 v137, s44, v49
  v_dot2c_f32_bf16 v139, v49, v49
  v_dot2c_f32_bf16 v136, s44, v50
  v_dot2c_f32_bf16 v138, v50, v50
  v_dot2c_f32_bf16 v137, s44, v51
  v_dot2c_f32_bf16 v139, v51, v51
  v_add_f32 v7, v198, v198
  v_mul_f32_e64 v197, v7, v7
  buffer_load_dwordx4 v14, s[16:19], s33 offen offset:1024 lds
  v_dot2c_f32_bf16 v136, s44, v52
  v_dot2c_f32_bf16 v138, v52, v52
  v_dot2c_f32_bf16 v137, s44, v53
  v_dot2c_f32_bf16 v139, v53, v53
  v_dot2c_f32_bf16 v136, s44, v54
  v_dot2c_f32_bf16 v138, v54, v54
  v_dot2c_f32_bf16 v137, s44, v55
  v_dot2c_f32_bf16 v139, v55, v55
  v_mul_f32_e64 v198, v6, v7
  v_fma_f32 v6, v6, v6, -v197
  buffer_load_dwordx4 v14, s[16:19], s34 offen offset:2048 lds
  v_dot2c_f32_bf16 v136, s44, v56
  v_dot2c_f32_bf16 v138, v56, v56
  v_dot2c_f32_bf16 v137, s44, v57
  v_dot2c_f32_bf16 v139, v57, v57
  v_dot2c_f32_bf16 v136, s44, v58
  v_dot2c_f32_bf16 v138, v58, v58
  v_dot2c_f32_bf16 v137, s44, v59
  v_dot2c_f32_bf16 v139, v59, v59
  v_add_f32 v7, v198, v198
  v_mul_f32 v197, v7, v7
  buffer_load_dwordx4 v14, s[16:19], s35 offen offset:3072 lds
  v_dot2c_f32_bf16 v136, s44, v60
  v_dot2c_f32_bf16 v138, v60, v60
  v_dot2c_f32_bf16 v137, s44, v61
  v_dot2c_f32_bf16 v139, v61, v61
  v_dot2c_f32_bf16 v136, s44, v62
  v_dot2c_f32_bf16 v138, v62, v62
  v_dot2c_f32_bf16 v137, s44, v63
  v_dot2c_f32_bf16 v139, v63, v63
  v_mul_f32_e64 v198, v6, v7
  v_fma_f32 v6, v6, v6, -v197
  s_waitcnt vmcnt(12)
  ds_read_b128 v[80:83], v188 offset:16384
  ds_read_b128 v[84:87], v189 offset:16384
  ds_read_b128 v[88:91], v190 offset:16384
  ds_read_b128 v[92:95], v191 offset:16384
  s_waitcnt lgkmcnt(4)
  s_add_u32 m0, s45, 118784
  s_nop 0
  buffer_load_dwordx4 v14, s[16:19], s36 offen offset:0 lds
  v_dot2c_f32_bf16 v136, s44, v64
  v_dot2c_f32_bf16 v138, v64, v64
  v_dot2c_f32_bf16 v137, s44, v65
  v_dot2c_f32_bf16 v139, v65, v65
  v_dot2c_f32_bf16 v136, s44, v66
  v_dot2c_f32_bf16 v138, v66, v66
  v_dot2c_f32_bf16 v137, s44, v67
  v_dot2c_f32_bf16 v139, v67, v67
  v_add_f32 v7, v198, v198
  v_mul_f32_e64 v197, v7, v7
  buffer_load_dwordx4 v14, s[16:19], s37 offen offset:1024 lds
  v_dot2c_f32_bf16 v136, s44, v68
  v_dot2c_f32_bf16 v138, v68, v68
  v_dot2c_f32_bf16 v137, s44, v69
  v_dot2c_f32_bf16 v139, v69, v69
  v_dot2c_f32_bf16 v136, s44, v70
  v_dot2c_f32_bf16 v138, v70, v70
  v_dot2c_f32_bf16 v137, s44, v71
  v_dot2c_f32_bf16 v139, v71, v71
  v_mul_f32_e64 v198, v6, v7
  v_fma_f32 v8, v6, v6, -v197
  buffer_load_dwordx4 v14, s[16:19], s38 offen offset:2048 lds
  v_add_u32 v14, 0x62000, v14
  v_dot2c_f32_bf16 v136, s44, v72
  v_dot2c_f32_bf16 v138, v72, v72
  v_dot2c_f32_bf16 v137, s44, v73
  v_dot2c_f32_bf16 v139, v73, v73
  v_dot2c_f32_bf16 v136, s44, v74
  v_dot2c_f32_bf16 v138, v74, v74
  v_dot2c_f32_bf16 v137, s44, v75
  v_dot2c_f32_bf16 v139, v75, v75
  v_add_f32_e64 v9, v198, v198
  v_mul_f32 v197, v9, v9
  v_dot2c_f32_bf16 v136, s44, v76
  v_dot2c_f32_bf16 v138, v76, v76
  v_dot2c_f32_bf16 v137, s44, v77
  v_dot2c_f32_bf16 v139, v77, v77
  v_dot2c_f32_bf16 v136, s44, v78
  v_dot2c_f32_bf16 v138, v78, v78
  v_dot2c_f32_bf16 v137, s44, v79
  v_dot2c_f32_bf16 v139, v79, v79
  v_mul_f32 v198, v8, v9
  v_fma_f32 v8, v8, v8, -v197
  s_waitcnt vmcnt(11)
  ds_read_b128 v[96:99], v188 offset:20480
  ds_read_b128 v[100:103], v189 offset:20480
  ds_read_b128 v[104:107], v190 offset:20480
  ds_read_b128 v[108:111], v191 offset:20480
  s_waitcnt lgkmcnt(4)
  v_dot2c_f32_bf16 v136, s44, v80
  v_dot2c_f32_bf16 v138, v80, v80
  v_dot2c_f32_bf16 v137, s44, v81
  v_dot2c_f32_bf16 v139, v81, v81
  v_dot2c_f32_bf16 v136, s44, v82
  v_dot2c_f32_bf16 v138, v82, v82
  v_dot2c_f32_bf16 v137, s44, v83
  v_dot2c_f32_bf16 v139, v83, v83
  v_add_f32_e64 v9, v198, v198
  v_mul_f32 v197, v9, v9
  v_dot2c_f32_bf16 v136, s44, v84
  v_dot2c_f32_bf16 v138, v84, v84
  v_dot2c_f32_bf16 v137, s44, v85
  v_dot2c_f32_bf16 v139, v85, v85
  v_dot2c_f32_bf16 v136, s44, v86
  v_dot2c_f32_bf16 v138, v86, v86
  v_dot2c_f32_bf16 v137, s44, v87
  v_dot2c_f32_bf16 v139, v87, v87
  v_mul_f32 v198, v8, v9
  v_fma_f32 v8, v8, v8, -v197
  v_dot2c_f32_bf16 v136, s44, v88
  v_dot2c_f32_bf16 v138, v88, v88
  v_dot2c_f32_bf16 v137, s44, v89
  v_dot2c_f32_bf16 v139, v89, v89
  v_dot2c_f32_bf16 v136, s44, v90
  v_dot2c_f32_bf16 v138, v90, v90
  v_dot2c_f32_bf16 v137, s44, v91
  v_dot2c_f32_bf16 v139, v91, v91
  v_add_f32 v9, v198, v198
  v_dot2c_f32_bf16 v136, s44, v92
  v_dot2c_f32_bf16 v138, v92, v92
  v_dot2c_f32_bf16 v137, s44, v93
  v_dot2c_f32_bf16 v139, v93, v93
  v_dot2c_f32_bf16 v136, s44, v94
  v_dot2c_f32_bf16 v138, v94, v94
  v_dot2c_f32_bf16 v137, s44, v95
  v_dot2c_f32_bf16 v139, v95, v95
  s_waitcnt vmcnt(7)
  ds_read_b128 v[112:115], v188 offset:24576
  ds_read_b128 v[116:119], v189 offset:24576
  ds_read_b128 v[120:123], v190 offset:24576
  ds_read_b128 v[124:127], v191 offset:24576
  s_waitcnt lgkmcnt(4)
  v_dot2c_f32_bf16 v136, s44, v96
  v_dot2c_f32_bf16 v138, v96, v96
  v_dot2c_f32_bf16 v137, s44, v97
  v_dot2c_f32_bf16 v139, v97, v97
  v_dot2c_f32_bf16 v136, s44, v98
  v_dot2c_f32_bf16 v138, v98, v98
  v_dot2c_f32_bf16 v137, s44, v99
  v_dot2c_f32_bf16 v139, v99, v99
  v_dot2c_f32_bf16 v136, s44, v100
  v_dot2c_f32_bf16 v138, v100, v100
  v_dot2c_f32_bf16 v137, s44, v101
  v_dot2c_f32_bf16 v139, v101, v101
  v_dot2c_f32_bf16 v136, s44, v102
  v_dot2c_f32_bf16 v138, v102, v102
  v_dot2c_f32_bf16 v137, s44, v103
  v_dot2c_f32_bf16 v139, v103, v103
  v_dot2c_f32_bf16 v136, s44, v104
  v_dot2c_f32_bf16 v138, v104, v104
  v_dot2c_f32_bf16 v137, s44, v105
  v_dot2c_f32_bf16 v139, v105, v105
  v_dot2c_f32_bf16 v136, s44, v106
  v_dot2c_f32_bf16 v138, v106, v106
  v_dot2c_f32_bf16 v137, s44, v107
  v_dot2c_f32_bf16 v139, v107, v107
  v_dot2c_f32_bf16 v136, s44, v108
  v_dot2c_f32_bf16 v138, v108, v108
  v_dot2c_f32_bf16 v137, s44, v109
  v_dot2c_f32_bf16 v139, v109, v109
  v_dot2c_f32_bf16 v136, s44, v110
  v_dot2c_f32_bf16 v138, v110, v110
  v_dot2c_f32_bf16 v137, s44, v111
  v_dot2c_f32_bf16 v139, v111, v111
  s_waitcnt lgkmcnt(0)
  s_barrier
  s_mov_b32 s40, 12288
  s_mov_b32 s41, 18432
  s_add_u32 m0, s45, 0
  s_nop 0
  buffer_load_dwordx4 v14, s[16:19], 0 offen offset:0 lds
  v_dot2c_f32_bf16 v136, s44, v112
  v_dot2c_f32_bf16 v138, v112, v112
  v_dot2c_f32_bf16 v137, s44, v113
  v_dot2c_f32_bf16 v139, v113, v113
  v_dot2c_f32_bf16 v136, s44, v114
  v_dot2c_f32_bf16 v138, v114, v114
  v_dot2c_f32_bf16 v137, s44, v115
  v_dot2c_f32_bf16 v139, v115, v115
  buffer_load_dwordx4 v14, s[16:19], s33 offen offset:1024 lds
  v_dot2c_f32_bf16 v136, s44, v116
  v_dot2c_f32_bf16 v138, v116, v116
  v_dot2c_f32_bf16 v137, s44, v117
  v_dot2c_f32_bf16 v139, v117, v117
  v_dot2c_f32_bf16 v136, s44, v118
  v_dot2c_f32_bf16 v138, v118, v118
  v_dot2c_f32_bf16 v137, s44, v119
  v_dot2c_f32_bf16 v139, v119, v119
  buffer_load_dwordx4 v14, s[16:19], s34 offen offset:2048 lds
  v_dot2c_f32_bf16 v136, s44, v120
  v_dot2c_f32_bf16 v138, v120, v120
  v_dot2c_f32_bf16 v137, s44, v121
  v_dot2c_f32_bf16 v139, v121, v121
  v_dot2c_f32_bf16 v136, s44, v122
  v_dot2c_f32_bf16 v138, v122, v122
  v_dot2c_f32_bf16 v137, s44, v123
  v_dot2c_f32_bf16 v139, v123, v123
  buffer_load_dwordx4 v14, s[16:19], s35 offen offset:3072 lds
  v_dot2c_f32_bf16 v136, s44, v124
  v_dot2c_f32_bf16 v138, v124, v124
  v_dot2c_f32_bf16 v137, s44, v125
  v_dot2c_f32_bf16 v139, v125, v125
  v_dot2c_f32_bf16 v136, s44, v126
  v_dot2c_f32_bf16 v138, v126, v126
  v_dot2c_f32_bf16 v137, s44, v127
  v_dot2c_f32_bf16 v139, v127, v127
  s_nop 1
  v_add_f32 v136, v136, v137
  v_add_f32 v138, v138, v139
  v_mov_b32 v137, v136
  v_mov_b32 v139, v138
  s_mov_b32 s44, 0x00003f80
  s_mov_b32 s48, 0x3f800000
  v_permlane32_swap_b32 v136, v137
  v_permlane32_swap_b32 v138, v139
  v_add_f32 v136, v136, v137
  v_add_f32_e64 v133, v138, v139
  v_mul_f32 v132, 0x3b124925, v136
  v_cvt_pk_bf16_f32 v134, v132, v132
  v_and_b32 v134, 0xffff0000, v134
  v_xor_b32 v215, 0x80000000, v134
  v_dot2_f32_bf16 v216, v16, s44, v215
  v_dot2_f32_bf16 v217, v16, s48, v215
  v_dot2_f32_bf16 v218, v17, s44, v215
  v_dot2_f32_bf16 v219, v17, s48, v215
  v_dot2_f32_bf16 v220, v18, s44, v215
  v_dot2_f32_bf16 v221, v18, s48, v215
  v_dot2_f32_bf16 v222, v19, s44, v215
  v_dot2_f32_bf16 v223, v19, s48, v215
  s_add_u32 m0, s45, 4096
  s_nop 0
  s_nop 0
  buffer_load_dwordx4 v14, s[16:19], s36 offen offset:0 lds
  v_cvt_pk_bf16_f32 v16, v216, v217
  v_cvt_pk_bf16_f32 v17, v218, v219
  v_cvt_pk_bf16_f32 v18, v220, v221
  v_cvt_pk_bf16_f32 v19, v222, v223
  v_dot2_f32_bf16 v216, v20, s44, v215
  v_dot2_f32_bf16 v217, v20, s48, v215
  v_dot2_f32_bf16 v218, v21, s44, v215
  v_dot2_f32_bf16 v219, v21, s48, v215
  v_dot2_f32_bf16 v220, v22, s44, v215
  v_dot2_f32_bf16 v221, v22, s48, v215
  v_dot2_f32_bf16 v222, v23, s44, v215
  v_dot2_f32_bf16 v223, v23, s48, v215
  v_cvt_pk_bf16_f32 v20, v216, v217
  v_cvt_pk_bf16_f32 v21, v218, v219
  v_cvt_pk_bf16_f32 v22, v220, v221
  v_cvt_pk_bf16_f32 v23, v222, v223
  v_dot2_f32_bf16 v216, v24, s44, v215
  v_dot2_f32_bf16 v217, v24, s48, v215
  v_dot2_f32_bf16 v218, v25, s44, v215
  v_dot2_f32_bf16 v219, v25, s48, v215
  v_dot2_f32_bf16 v220, v26, s44, v215
  v_dot2_f32_bf16 v221, v26, s48, v215
  v_dot2_f32_bf16 v222, v27, s44, v215
  v_dot2_f32_bf16 v223, v27, s48, v215
  buffer_load_dwordx4 v14, s[16:19], s37 offen offset:1024 lds
  v_cvt_pk_bf16_f32 v24, v216, v217
  v_cvt_pk_bf16_f32 v25, v218, v219
  v_cvt_pk_bf16_f32 v26, v220, v221
  v_cvt_pk_bf16_f32 v27, v222, v223
  v_dot2_f32_bf16 v216, v28, s44, v215
  v_dot2_f32_bf16 v217, v28, s48, v215
  v_dot2_f32_bf16 v218, v29, s44, v215
  v_dot2_f32_bf16 v219, v29, s48, v215
  v_dot2_f32_bf16 v220, v30, s44, v215
  v_dot2_f32_bf16 v221, v30, s48, v215
  v_dot2_f32_bf16 v222, v31, s44, v215
  v_dot2_f32_bf16 v223, v31, s48, v215
  v_cvt_pk_bf16_f32 v28, v216, v217
  v_cvt_pk_bf16_f32 v29, v218, v219
  v_cvt_pk_bf16_f32 v30, v220, v221
  v_cvt_pk_bf16_f32 v31, v222, v223
  v_dot2_f32_bf16 v216, v32, s44, v215
  v_dot2_f32_bf16 v217, v32, s48, v215
  v_dot2_f32_bf16 v218, v33, s44, v215
  v_dot2_f32_bf16 v219, v33, s48, v215
  v_dot2_f32_bf16 v220, v34, s44, v215
  v_dot2_f32_bf16 v221, v34, s48, v215
  v_dot2_f32_bf16 v222, v35, s44, v215
  v_dot2_f32_bf16 v223, v35, s48, v215
  buffer_load_dwordx4 v14, s[16:19], s38 offen offset:2048 lds
  v_add_u32 v14, 0x62000, v14
  v_cvt_pk_bf16_f32 v32, v216, v217
  v_cvt_pk_bf16_f32 v33, v218, v219
  v_cvt_pk_bf16_f32 v34, v220, v221
  v_cvt_pk_bf16_f32 v35, v222, v223
  v_dot2_f32_bf16 v216, v36, s44, v215
  v_dot2_f32_bf16 v217, v36, s48, v215
  v_dot2_f32_bf16 v218, v37, s44, v215
  v_dot2_f32_bf16 v219, v37, s48, v215
  v_dot2_f32_bf16 v220, v38, s44, v215
  v_dot2_f32_bf16 v221, v38, s48, v215
  v_dot2_f32_bf16 v222, v39, s44, v215
  v_dot2_f32_bf16 v223, v39, s48, v215
  v_cvt_pk_bf16_f32 v36, v216, v217
  v_cvt_pk_bf16_f32 v37, v218, v219
  v_cvt_pk_bf16_f32 v38, v220, v221
  v_cvt_pk_bf16_f32 v39, v222, v223
  v_dot2_f32_bf16 v216, v40, s44, v215
  v_dot2_f32_bf16 v217, v40, s48, v215
  v_dot2_f32_bf16 v218, v41, s44, v215
  v_dot2_f32_bf16 v219, v41, s48, v215
  v_dot2_f32_bf16 v220, v42, s44, v215
  v_dot2_f32_bf16 v221, v42, s48, v215
  v_dot2_f32_bf16 v222, v43, s44, v215
  v_dot2_f32_bf16 v223, v43, s48, v215
  s_add_u32 m0, s81, 0
  s_nop 0
  buffer_load_dwordx4 v224, s[68:71], 0 offen offset:0 lds
  v_cvt_pk_bf16_f32 v40, v216, v217
  v_cvt_pk_bf16_f32 v41, v218, v219
  v_cvt_pk_bf16_f32 v42, v220, v221
  v_cvt_pk_bf16_f32 v43, v222, v223
  v_dot2_f32_bf16 v216, v44, s44, v215
  v_dot2_f32_bf16 v217, v44, s48, v215
  v_dot2_f32_bf16 v218, v45, s44, v215
  v_dot2_f32_bf16 v219, v45, s48, v215
  v_dot2_f32_bf16 v220, v46, s44, v215
  v_dot2_f32_bf16 v221, v46, s48, v215
  v_dot2_f32_bf16 v222, v47, s44, v215
  v_dot2_f32_bf16 v223, v47, s48, v215
  v_cvt_pk_bf16_f32 v44, v216, v217
  v_cvt_pk_bf16_f32 v45, v218, v219
  v_cvt_pk_bf16_f32 v46, v220, v221
  v_cvt_pk_bf16_f32 v47, v222, v223
  v_dot2_f32_bf16 v216, v48, s44, v215
  v_dot2_f32_bf16 v217, v48, s48, v215
  v_dot2_f32_bf16 v218, v49, s44, v215
  v_dot2_f32_bf16 v219, v49, s48, v215
  v_dot2_f32_bf16 v220, v50, s44, v215
  v_dot2_f32_bf16 v221, v50, s48, v215
  v_dot2_f32_bf16 v222, v51, s44, v215
  v_dot2_f32_bf16 v223, v51, s48, v215
  buffer_load_dwordx4 v224, s[68:71], s39 offen offset:1024 lds
  v_cvt_pk_bf16_f32 v48, v216, v217
  v_cvt_pk_bf16_f32 v49, v218, v219
  v_cvt_pk_bf16_f32 v50, v220, v221
  v_cvt_pk_bf16_f32 v51, v222, v223
  v_dot2_f32_bf16 v216, v52, s44, v215
  v_dot2_f32_bf16 v217, v52, s48, v215
  v_dot2_f32_bf16 v218, v53, s44, v215
  v_dot2_f32_bf16 v219, v53, s48, v215
  v_dot2_f32_bf16 v220, v54, s44, v215
  v_dot2_f32_bf16 v221, v54, s48, v215
  v_dot2_f32_bf16 v222, v55, s44, v215
  v_dot2_f32_bf16 v223, v55, s48, v215
  v_cvt_pk_bf16_f32 v52, v216, v217
  v_cvt_pk_bf16_f32 v53, v218, v219
  v_cvt_pk_bf16_f32 v54, v220, v221
  v_cvt_pk_bf16_f32 v55, v222, v223
  v_dot2_f32_bf16 v216, v56, s44, v215
  v_dot2_f32_bf16 v217, v56, s48, v215
  v_dot2_f32_bf16 v218, v57, s44, v215
  v_dot2_f32_bf16 v219, v57, s48, v215
  v_dot2_f32_bf16 v220, v58, s44, v215
  v_dot2_f32_bf16 v221, v58, s48, v215
  v_dot2_f32_bf16 v222, v59, s44, v215
  v_dot2_f32_bf16 v223, v59, s48, v215
  buffer_load_dwordx4 v224, s[68:71], s40 offen offset:2048 lds
  v_cvt_pk_bf16_f32 v56, v216, v217
  v_cvt_pk_bf16_f32 v57, v218, v219
  v_cvt_pk_bf16_f32 v58, v220, v221
  v_cvt_pk_bf16_f32 v59, v222, v223
  v_dot2_f32_bf16 v216, v60, s44, v215
  v_dot2_f32_bf16 v217, v60, s48, v215
  v_dot2_f32_bf16 v218, v61, s44, v215
  v_dot2_f32_bf16 v219, v61, s48, v215
  v_dot2_f32_bf16 v220, v62, s44, v215
  v_dot2_f32_bf16 v221, v62, s48, v215
  v_dot2_f32_bf16 v222, v63, s44, v215
  v_dot2_f32_bf16 v223, v63, s48, v215
  v_cvt_pk_bf16_f32 v60, v216, v217
  v_cvt_pk_bf16_f32 v61, v218, v219
  v_cvt_pk_bf16_f32 v62, v220, v221
  v_cvt_pk_bf16_f32 v63, v222, v223
  v_dot2_f32_bf16 v216, v64, s44, v215
  v_dot2_f32_bf16 v217, v64, s48, v215
  v_dot2_f32_bf16 v218, v65, s44, v215
  v_dot2_f32_bf16 v219, v65, s48, v215
  v_dot2_f32_bf16 v220, v66, s44, v215
  v_dot2_f32_bf16 v221, v66, s48, v215
  v_dot2_f32_bf16 v222, v67, s44, v215
  v_dot2_f32_bf16 v223, v67, s48, v215
  buffer_load_dwordx4 v224, s[68:71], s41 offen offset:3072 lds
  v_add_u32 v224, 28672, v224
  v_cvt_pk_bf16_f32 v64, v216, v217
  v_cvt_pk_bf16_f32 v65, v218, v219
  v_cvt_pk_bf16_f32 v66, v220, v221
  v_cvt_pk_bf16_f32 v67, v222, v223
  v_dot2_f32_bf16 v216, v68, s44, v215
  v_dot2_f32_bf16 v217, v68, s48, v215
  v_dot2_f32_bf16 v218, v69, s44, v215
  v_dot2_f32_bf16 v219, v69, s48, v215
  v_dot2_f32_bf16 v220, v70, s44, v215
  v_dot2_f32_bf16 v221, v70, s48, v215
  v_dot2_f32_bf16 v222, v71, s44, v215
  v_dot2_f32_bf16 v223, v71, s48, v215
  v_cvt_pk_bf16_f32 v68, v216, v217
  v_cvt_pk_bf16_f32 v69, v218, v219
  v_cvt_pk_bf16_f32 v70, v220, v221
  v_cvt_pk_bf16_f32 v71, v222, v223
  v_dot2_f32_bf16 v216, v72, s44, v215
  v_dot2_f32_bf16 v217, v72, s48, v215
  v_dot2_f32_bf16 v218, v73, s44, v215
  v_dot2_f32_bf16 v219, v73, s48, v215
  v_dot2_f32_bf16 v220, v74, s44, v215
  v_dot2_f32_bf16 v221, v74, s48, v215
  v_dot2_f32_bf16 v222, v75, s44, v215
  v_dot2_f32_bf16 v223, v75, s48, v215
  s_add_u32 m0, s81, 4096
  s_nop 0
  s_nop 0
  buffer_load_dwordx4 v224, s[68:71], 0 offen offset:0 lds
  v_cvt_pk_bf16_f32 v72, v216, v217
  v_cvt_pk_bf16_f32 v73, v218, v219
  v_cvt_pk_bf16_f32 v74, v220, v221
  v_cvt_pk_bf16_f32 v75, v222, v223
  v_dot2_f32_bf16 v216, v76, s44, v215
  v_dot2_f32_bf16 v217, v76, s48, v215
  v_dot2_f32_bf16 v218, v77, s44, v215
  v_dot2_f32_bf16 v219, v77, s48, v215
  v_dot2_f32_bf16 v220, v78, s44, v215
  v_dot2_f32_bf16 v221, v78, s48, v215
  v_dot2_f32_bf16 v222, v79, s44, v215
  v_dot2_f32_bf16 v223, v79, s48, v215
  v_cvt_pk_bf16_f32 v76, v216, v217
  v_cvt_pk_bf16_f32 v77, v218, v219
  v_cvt_pk_bf16_f32 v78, v220, v221
  v_cvt_pk_bf16_f32 v79, v222, v223
  v_dot2_f32_bf16 v216, v80, s44, v215
  v_dot2_f32_bf16 v217, v80, s48, v215
  v_dot2_f32_bf16 v218, v81, s44, v215
  v_dot2_f32_bf16 v219, v81, s48, v215
  v_dot2_f32_bf16 v220, v82, s44, v215
  v_dot2_f32_bf16 v221, v82, s48, v215
  v_dot2_f32_bf16 v222, v83, s44, v215
  v_dot2_f32_bf16 v223, v83, s48, v215
  buffer_load_dwordx4 v224, s[68:71], s39 offen offset:1024 lds
  v_add_u32 v224, 14336, v224
  v_cvt_pk_bf16_f32 v80, v216, v217
  v_cvt_pk_bf16_f32 v81, v218, v219
  v_cvt_pk_bf16_f32 v82, v220, v221
  v_cvt_pk_bf16_f32 v83, v222, v223
  v_dot2_f32_bf16 v216, v84, s44, v215
  v_dot2_f32_bf16 v217, v84, s48, v215
  v_dot2_f32_bf16 v218, v85, s44, v215
  v_dot2_f32_bf16 v219, v85, s48, v215
  v_dot2_f32_bf16 v220, v86, s44, v215
  v_dot2_f32_bf16 v221, v86, s48, v215
  v_dot2_f32_bf16 v222, v87, s44, v215
  v_dot2_f32_bf16 v223, v87, s48, v215
  v_cvt_pk_bf16_f32 v84, v216, v217
  v_cvt_pk_bf16_f32 v85, v218, v219
  v_cvt_pk_bf16_f32 v86, v220, v221
  v_cvt_pk_bf16_f32 v87, v222, v223
  v_dot2_f32_bf16 v216, v88, s44, v215
  v_dot2_f32_bf16 v217, v88, s48, v215
  v_dot2_f32_bf16 v218, v89, s44, v215
  v_dot2_f32_bf16 v219, v89, s48, v215
  v_dot2_f32_bf16 v220, v90, s44, v215
  v_dot2_f32_bf16 v221, v90, s48, v215
  v_dot2_f32_bf16 v222, v91, s44, v215
  v_dot2_f32_bf16 v223, v91, s48, v215
  s_add_u32 m0, s45, 28672
  s_nop 0
  s_nop 0
  buffer_load_dwordx4 v14, s[16:19], 0 offen offset:0 lds
  v_cvt_pk_bf16_f32 v88, v216, v217
  v_cvt_pk_bf16_f32 v89, v218, v219
  v_cvt_pk_bf16_f32 v90, v220, v221
  v_cvt_pk_bf16_f32 v91, v222, v223
  v_dot2_f32_bf16 v216, v92, s44, v215
  v_dot2_f32_bf16 v217, v92, s48, v215
  v_dot2_f32_bf16 v218, v93, s44, v215
  v_dot2_f32_bf16 v219, v93, s48, v215
  v_dot2_f32_bf16 v220, v94, s44, v215
  v_dot2_f32_bf16 v221, v94, s48, v215
  v_dot2_f32_bf16 v222, v95, s44, v215
  v_dot2_f32_bf16 v223, v95, s48, v215
  v_cvt_pk_bf16_f32 v92, v216, v217
  v_cvt_pk_bf16_f32 v93, v218, v219
  v_cvt_pk_bf16_f32 v94, v220, v221
  v_cvt_pk_bf16_f32 v95, v222, v223
  v_dot2_f32_bf16 v216, v96, s44, v215
  v_dot2_f32_bf16 v217, v96, s48, v215
  v_dot2_f32_bf16 v218, v97, s44, v215
  v_dot2_f32_bf16 v219, v97, s48, v215
  v_dot2_f32_bf16 v220, v98, s44, v215
  v_dot2_f32_bf16 v221, v98, s48, v215
  v_dot2_f32_bf16 v222, v99, s44, v215
  v_dot2_f32_bf16 v223, v99, s48, v215
  buffer_load_dwordx4 v14, s[16:19], s33 offen offset:1024 lds
  v_cvt_pk_bf16_f32 v96, v216, v217
  v_cvt_pk_bf16_f32 v97, v218, v219
  v_cvt_pk_bf16_f32 v98, v220, v221
  v_cvt_pk_bf16_f32 v99, v222, v223
  v_dot2_f32_bf16 v216, v100, s44, v215
  v_dot2_f32_bf16 v217, v100, s48, v215
  v_dot2_f32_bf16 v218, v101, s44, v215
  v_dot2_f32_bf16 v219, v101, s48, v215
  v_dot2_f32_bf16 v220, v102, s44, v215
  v_dot2_f32_bf16 v221, v102, s48, v215
  v_dot2_f32_bf16 v222, v103, s44, v215
  v_dot2_f32_bf16 v223, v103, s48, v215
  v_cvt_pk_bf16_f32 v100, v216, v217
  v_cvt_pk_bf16_f32 v101, v218, v219
  v_cvt_pk_bf16_f32 v102, v220, v221
  v_cvt_pk_bf16_f32 v103, v222, v223
  v_dot2_f32_bf16 v216, v104, s44, v215
  v_dot2_f32_bf16 v217, v104, s48, v215
  v_dot2_f32_bf16 v218, v105, s44, v215
  v_dot2_f32_bf16 v219, v105, s48, v215
  v_dot2_f32_bf16 v220, v106, s44, v215
  v_dot2_f32_bf16 v221, v106, s48, v215
  v_dot2_f32_bf16 v222, v107, s44, v215
  v_dot2_f32_bf16 v223, v107, s48, v215
  buffer_load_dwordx4 v14, s[16:19], s34 offen offset:2048 lds
  v_cvt_pk_bf16_f32 v104, v216, v217
  v_cvt_pk_bf16_f32 v105, v218, v219
  v_cvt_pk_bf16_f32 v106, v220, v221
  v_cvt_pk_bf16_f32 v107, v222, v223
  v_dot2_f32_bf16 v216, v108, s44, v215
  v_dot2_f32_bf16 v217, v108, s48, v215
  v_dot2_f32_bf16 v218, v109, s44, v215
  v_dot2_f32_bf16 v219, v109, s48, v215
  v_dot2_f32_bf16 v220, v110, s44, v215
  v_dot2_f32_bf16 v221, v110, s48, v215
  v_dot2_f32_bf16 v222, v111, s44, v215
  v_dot2_f32_bf16 v223, v111, s48, v215
  v_cvt_pk_bf16_f32 v108, v216, v217
  v_cvt_pk_bf16_f32 v109, v218, v219
  v_cvt_pk_bf16_f32 v110, v220, v221
  v_cvt_pk_bf16_f32 v111, v222, v223
  v_dot2_f32_bf16 v216, v112, s44, v215
  v_dot2_f32_bf16 v217, v112, s48, v215
  v_dot2_f32_bf16 v218, v113, s44, v215
  v_dot2_f32_bf16 v219, v113, s48, v215
  v_dot2_f32_bf16 v220, v114, s44, v215
  v_dot2_f32_bf16 v221, v114, s48, v215
  v_dot2_f32_bf16 v222, v115, s44, v215
  v_dot2_f32_bf16 v223, v115, s48, v215
  buffer_load_dwordx4 v14, s[16:19], s35 offen offset:3072 lds
  v_cvt_pk_bf16_f32 v112, v216, v217
  v_cvt_pk_bf16_f32 v113, v218, v219
  v_cvt_pk_bf16_f32 v114, v220, v221
  v_cvt_pk_bf16_f32 v115, v222, v223
  v_dot2_f32_bf16 v216, v116, s44, v215
  v_dot2_f32_bf16 v217, v116, s48, v215
  v_dot2_f32_bf16 v218, v117, s44, v215
  v_dot2_f32_bf16 v219, v117, s48, v215
  v_dot2_f32_bf16 v220, v118, s44, v215
  v_dot2_f32_bf16 v221, v118, s48, v215
  v_dot2_f32_bf16 v222, v119, s44, v215
  v_dot2_f32_bf16 v223, v119, s48, v215
  v_cvt_pk_bf16_f32 v116, v216, v217
  v_cvt_pk_bf16_f32 v117, v218, v219
  v_cvt_pk_bf16_f32 v118, v220, v221
  v_cvt_pk_bf16_f32 v119, v222, v223
  v_dot2_f32_bf16 v216, v120, s44, v215
  v_dot2_f32_bf16 v217, v120, s48, v215
  v_dot2_f32_bf16 v218, v121, s44, v215
  v_dot2_f32_bf16 v219, v121, s48, v215
  v_dot2_f32_bf16 v220, v122, s44, v215
  v_dot2_f32_bf16 v221, v122, s48, v215
  v_dot2_f32_bf16 v222, v123, s44, v215
  v_dot2_f32_bf16 v223, v123, s48, v215
  s_add_u32 m0, s45, 32768
  s_nop 0
  buffer_load_dwordx4 v14, s[16:19], s36 offen offset:0 lds
  s_waitcnt vmcnt(18)
  s_barrier
  s_nop 0
  ds_read_b64_tr_b16 a[64:65], v140 offset:0
  ds_read_b64_tr_b16 a[66:67], v140 offset:512
  ds_read_b64_tr_b16 a[68:69], v141 offset:0
  ds_read_b64_tr_b16 a[70:71], v141 offset:512
  ds_read_b64_tr_b16 a[72:73], v140 offset:14336
  ds_read_b64_tr_b16 a[74:75], v140 offset:14848
  ds_read_b64_tr_b16 a[76:77], v141 offset:14336
  ds_read_b64_tr_b16 a[78:79], v141 offset:14848
  ds_read_b64_tr_b16 a[80:81], v140 offset:2048
  ds_read_b64_tr_b16 a[82:83], v140 offset:2560
  ds_read_b64_tr_b16 a[84:85], v141 offset:2048
  ds_read_b64_tr_b16 a[86:87], v141 offset:2560
  ds_read_b64_tr_b16 a[88:89], v140 offset:16384
  ds_read_b64_tr_b16 a[90:91], v140 offset:16896
  v_cvt_pk_bf16_f32 v120, v216, v217
  v_cvt_pk_bf16_f32 v121, v218, v219
  v_cvt_pk_bf16_f32 v122, v220, v221
  v_cvt_pk_bf16_f32 v123, v222, v223
  v_dot2_f32_bf16 v216, v124, s44, v215
  v_dot2_f32_bf16 v217, v124, s48, v215
  v_dot2_f32_bf16 v218, v125, s44, v215
  v_dot2_f32_bf16 v219, v125, s48, v215
  v_dot2_f32_bf16 v220, v126, s44, v215
  v_dot2_f32_bf16 v221, v126, s48, v215
  v_dot2_f32_bf16 v222, v127, s44, v215
  v_dot2_f32_bf16 v223, v127, s48, v215
  v_cvt_pk_bf16_f32 v124, v216, v217
  v_cvt_pk_bf16_f32 v125, v218, v219
  v_cvt_pk_bf16_f32 v126, v220, v221
  v_cvt_pk_bf16_f32 v127, v222, v223
  s_waitcnt lgkmcnt(12)
  v_mfma_f32_32x32x16_bf16 v[160:175], a[64:67], v[16:19], 0
  ds_read_b64_tr_b16 a[92:93], v141 offset:16384
  ds_read_b64_tr_b16 a[94:95], v141 offset:16896
  s_waitcnt lgkmcnt(6)
  buffer_load_dwordx4 v14, s[16:19], s37 offen offset:1024 lds
  v_lshl_add_u32 v144, v128, 9, v144
  s_lshl_b32 s49, s46, 6
  v_mfma_f32_32x32x16_bf16 v[176:191], a[68:71], v[16:19], 0
  ds_read_b64_tr_b16 a[64:65], v140 offset:4096
  ds_read_b64_tr_b16 a[66:67], v140 offset:4608
  v_xor_b32 v144, s49, v144
  v_add_u32 v142, s81, v144
  v_xor_b32 v143, 64, v142
  v_mfma_f32_32x32x16_bf16 v[192:207], a[72:75], v[16:19], 0
  ds_read_b64_tr_b16 a[68:69], v141 offset:4096
  ds_read_b64_tr_b16 a[70:71], v141 offset:4608
  buffer_load_dwordx4 v14, s[16:19], s38 offen offset:2048 lds
  v_add_u32 v14, 0x62000, v14
  s_mul_i32 s80, s3, 10240
  v_mfma_f32_32x32x16_bf16 v[208:223], a[76:79], v[16:19], 0
  ds_read_b64_tr_b16 a[72:73], v140 offset:18432
  ds_read_b64_tr_b16 a[74:75], v140 offset:18944
  s_waitcnt vmcnt(7)
  ds_read_b64_tr_b16 a[96:97], v142 offset:0
  ds_read_b64_tr_b16 a[98:99], v142 offset:1024
  v_mfma_f32_32x32x16_bf16 v[160:175], a[80:83], v[20:23], v[160:175]
  s_add_u32 m0, s45, 57344
  ds_read_b64_tr_b16 a[76:77], v141 offset:18432
  ds_read_b64_tr_b16 a[78:79], v141 offset:18944
  s_waitcnt lgkmcnt(8)
  buffer_load_dwordx4 v14, s[16:19], 0 offen offset:0 lds
  ds_read_b64_tr_b16 a[100:101], v143 offset:0
  v_mfma_f32_32x32x16_bf16 v[176:191], a[84:87], v[20:23], v[176:191]
  ds_read_b64_tr_b16 a[80:81], v140 offset:6144
  ds_read_b64_tr_b16 a[82:83], v140 offset:6656
  ds_read_b64_tr_b16 a[102:103], v143 offset:1024
  ds_read_b64_tr_b16 a[104:105], v142 offset:2048
  s_add_u32 s80, s80, 114688
  v_mfma_f32_32x32x16_bf16 v[192:207], a[88:91], v[20:23], v[192:207]
  ds_read_b64_tr_b16 a[84:85], v141 offset:6144
  ds_read_b64_tr_b16 a[86:87], v141 offset:6656
  buffer_load_dwordx4 v14, s[16:19], s33 offen offset:1024 lds
  ds_read_b64_tr_b16 a[106:107], v142 offset:3072
  v_add_u32_e64 v225, s80, v144
  v_mfma_f32_32x32x16_bf16 v[208:223], a[92:95], v[20:23], v[208:223]
  ds_read_b64_tr_b16 a[88:89], v140 offset:20480
  ds_read_b64_tr_b16 a[90:91], v140 offset:20992
  ds_read_b64_tr_b16 a[108:109], v143 offset:2048
  ds_read_b64_tr_b16 a[110:111], v143 offset:3072
  v_xor_b32_e64 v226, 64, v225
  v_mfma_f32_32x32x16_bf16 v[160:175], a[64:67], v[24:27], v[160:175]
  ds_read_b64_tr_b16 a[92:93], v141 offset:20480
  ds_read_b64_tr_b16 a[94:95], v141 offset:20992
  s_waitcnt lgkmcnt(11)
  ds_read_b64_tr_b16 a[112:113], v142 offset:4096
  v_add_u32 v252, 57344, v12
  v_mfma_f32_32x32x16_bf16 v[176:191], a[68:71], v[24:27], v[176:191]
  ds_read_b64_tr_b16 a[64:65], v140 offset:8192
  ds_read_b64_tr_b16 a[66:67], v140 offset:8704
  ds_read_b64_tr_b16 a[114:115], v142 offset:5120
  ds_read_b64_tr_b16 a[116:117], v143 offset:4096
  v_add_u32 v253, 57344, v13
  v_mfma_f32_32x32x16_bf16 v[192:207], a[72:75], v[24:27], v[192:207]
  ds_read_b64_tr_b16 a[68:69], v141 offset:8192
  ds_read_b64_tr_b16 a[70:71], v141 offset:8704
  ds_read_b64_tr_b16 a[118:119], v143 offset:5120
  s_mov_b32 s14, 401408
  s_mov_b32 s15, 0x20000
  v_mfma_f32_32x32x16_bf16 v[208:223], a[76:79], v[24:27], v[208:223]
  ds_read_b64_tr_b16 a[72:73], v140 offset:22528
  ds_read_b64_tr_b16 a[74:75], v140 offset:23040
  s_waitcnt lgkmcnt(2)
  s_mov_b32 s94, 401408
  s_mov_b32 s95, 0x20000
  v_mfma_f32_32x32x16_bf16 v[160:175], a[80:83], v[28:31], v[160:175]
  s_add_u32 m0, s81, 0
  ds_read_b64_tr_b16 a[76:77], v141 offset:22528
  ds_read_b64_tr_b16 a[78:79], v141 offset:23040
  buffer_load_dwordx4 v224, s[68:71], 0 offen offset:0 lds
  s_mul_i32 s47, s29, 28672
  v_mfma_f32_32x32x16_bf16 v[176:191], a[84:87], v[28:31], v[176:191]
  ds_read_b64_tr_b16 a[80:81], v140 offset:10240
  ds_read_b64_tr_b16 a[82:83], v140 offset:10752
  s_lshl_b32 s42, s3, 10
  v_mul_f32 v133, 0x3b124925, v133
  v_fma_f32 v133, -v132, v132, v133
  v_mfma_f32_32x32x16_bf16 v[192:207], a[88:91], v[28:31], v[192:207]
  ds_read_b64_tr_b16 a[84:85], v141 offset:10240
  ds_read_b64_tr_b16 a[86:87], v141 offset:10752
  buffer_load_dwordx4 v224, s[68:71], s39 offen offset:1024 lds
  v_max_f32 v133, 0, v133
  v_lshlrev_b32 v1, 4, v0
  v_mfma_f32_32x32x16_bf16 v[208:223], a[92:95], v[28:31], v[208:223]
  ds_read_b64_tr_b16 a[88:89], v140 offset:24576
  ds_read_b64_tr_b16 a[90:91], v140 offset:25088
  v_cvt_pk_bf16_f32 v133, v133, v133
  v_and_b32 v133, 0xffff0000, v133
  v_add_f32 v133, 0x3727c5ac, v133
  v_mfma_f32_32x32x16_bf16 v[160:175], a[64:67], v[32:35], v[160:175]
  ds_read_b64_tr_b16 a[92:93], v141 offset:24576
  ds_read_b64_tr_b16 a[94:95], v141 offset:25088
  s_waitcnt lgkmcnt(6)
  buffer_load_dwordx4 v224, s[68:71], s40 offen offset:2048 lds
  v_cvt_pk_bf16_f32 v133, v133, v133
  v_mfma_f32_32x32x16_bf16 v[176:191], a[68:71], v[32:35], v[176:191]
  ds_read_b64_tr_b16 a[64:65], v140 offset:12288
  ds_read_b64_tr_b16 a[66:67], v140 offset:12800
  v_and_b32 v133, 0xffff0000, v133
  v_sqrt_f32_e64 v133, v133
  s_mov_b32 s24, s20
  v_mfma_f32_32x32x16_bf16 v[192:207], a[72:75], v[32:35], v[192:207]
  ds_read_b64_tr_b16 a[68:69], v141 offset:12288
  ds_read_b64_tr_b16 a[70:71], v141 offset:12800
  buffer_load_dwordx4 v224, s[68:71], s41 offen offset:3072 lds
  v_add_u32 v224, 28672, v224
  v_cvt_pk_bf16_f32 v133, v133, v133
  v_mfma_f32_32x32x16_bf16 v[208:223], a[76:79], v[32:35], v[208:223]
  ds_read_b64_tr_b16 a[72:73], v140 offset:26624
  ds_read_b64_tr_b16 a[74:75], v140 offset:27136
  v_and_b32 v133, 0xffff0000, v133
  v_rcp_f32 v135, v133
  s_mov_b32 s25, s21
  v_mfma_f32_32x32x16_bf16 v[160:175], a[80:83], v[36:39], v[160:175]
  s_add_u32 m0, s81, 4096
  ds_read_b64_tr_b16 a[76:77], v141 offset:26624
  ds_read_b64_tr_b16 a[78:79], v141 offset:27136
  s_waitcnt lgkmcnt(6)
  buffer_load_dwordx4 v224, s[68:71], 0 offen offset:0 lds
  v_mfma_f32_32x32x16_bf16 v[176:191], a[84:87], v[36:39], v[176:191]
  s_barrier
  ds_read_b64_tr_b16 a[80:81], v12 offset:0
  ds_read_b64_tr_b16 a[82:83], v12 offset:512
  s_mov_b32 s26, 256
  s_mov_b32 s27, 0x20000
  v_mfma_f32_32x32x16_bf16 v[192:207], a[88:91], v[36:39], v[192:207]
  ds_read_b64_tr_b16 a[84:85], v13 offset:0
  ds_read_b64_tr_b16 a[86:87], v13 offset:512
  buffer_load_dwordx4 v224, s[68:71], s39 offen offset:1024 lds
  v_add_u32 v224, 14336, v224
  s_mov_b32 s20, s22
  v_mfma_f32_32x32x16_bf16 v[208:223], a[92:95], v[36:39], v[208:223]
  ds_read_b64_tr_b16 a[88:89], v12 offset:14336
  ds_read_b64_tr_b16 a[90:91], v12 offset:14848
  s_mov_b32 s21, s23
  s_mov_b32 s22, 11165696
  s_mov_b32 s23, 0x20000
  v_mfma_f32_32x32x16_bf16 v[160:175], a[64:67], v[40:43], v[160:175]
  ds_read_b64_tr_b16 a[92:93], v13 offset:14336
  ds_read_b64_tr_b16 a[94:95], v13 offset:14848
  s_waitcnt lgkmcnt(6)
  s_lshl_b32 s55, s31, 8
  s_add_u32 s55, s55, 11010048
  v_mfma_f32_32x32x16_bf16 v[176:191], a[68:71], v[40:43], v[176:191]
  s_add_u32 m0, s45, 57344
  ds_read_b64_tr_b16 a[64:65], v12 offset:2048
  ds_read_b64_tr_b16 a[66:67], v12 offset:2560
  buffer_load_dwordx4 v14, s[16:19], s34 offen offset:2048 lds
  s_lshl_b32 s49, s3, 7
  v_mfma_f32_32x32x16_bf16 v[192:207], a[72:75], v[40:43], v[192:207]
  ds_read_b64_tr_b16 a[68:69], v13 offset:2048
  ds_read_b64_tr_b16 a[70:71], v13 offset:2560
  s_add_u32 s49, s49, 155648
  v_lshl_add_u32 v145, v131, 2, s49
  v_lshlrev_b32 v131, 3, v131
  v_mfma_f32_32x32x16_bf16 v[208:223], a[76:79], v[40:43], v[208:223]
  ds_read_b64_tr_b16 a[72:73], v12 offset:16384
  ds_read_b64_tr_b16 a[74:75], v12 offset:16896
  v_lshl_add_u32 v251, v128, 6, s49
  buffer_store_dwordx2 v[134:135], v131, s[20:23], s55 offen sc1
  ds_write_b32 v145, v135
  v_mfma_f32_32x32x16_bf16 v[160:175], a[80:83], v[44:47], v[160:175]
  ds_read_b64_tr_b16 a[76:77], v13 offset:16384
  ds_read_b64_tr_b16 a[78:79], v13 offset:16896
  s_waitcnt lgkmcnt(7)
  buffer_load_dword v227, off, s[24:27], 0 sc1
  v_lshlrev_b32 v255, 3, v129
  v_mfma_f32_32x32x16_bf16 v[176:191], a[84:87], v[44:47], v[176:191]
  ds_read_b64_tr_b16 a[80:81], v12 offset:4096
  ds_read_b64_tr_b16 a[82:83], v12 offset:4608
  buffer_load_dwordx4 v14, s[16:19], s35 offen offset:3072 lds
  v_lshl_add_u32 v254, v128, 8, v255
  s_lshl_b32 s49, s3, 9
  v_mfma_f32_32x32x16_bf16 v[192:207], a[88:91], v[44:47], v[192:207]
  ds_read_b64_tr_b16 a[84:85], v13 offset:4096
  ds_read_b64_tr_b16 a[86:87], v13 offset:4608
  s_add_u32 s49, s49, 159744
  v_add_u32 v254, s49, v254
  v_mov_b32_e64 v152, 0
  v_mfma_f32_32x32x16_bf16 v[208:223], a[92:95], v[44:47], v[208:223]
  ds_read_b64_tr_b16 a[88:89], v12 offset:18432
  ds_read_b64_tr_b16 a[90:91], v12 offset:18944
  v_mov_b32_e64 v153, 0
  v_mov_b32 v154, 0
  v_mov_b32 v155, 0
  v_mfma_f32_32x32x16_bf16 v[160:175], a[64:67], v[48:51], v[160:175]
  ds_read_b64_tr_b16 a[92:93], v13 offset:18432
  ds_read_b64_tr_b16 a[94:95], v13 offset:18944
  s_waitcnt lgkmcnt(6)
  v_add_u32 v151, 159744, v1
  v_lshlrev_b32 v146, 7, v129
  v_mfma_f32_32x32x16_bf16 v[176:191], a[68:71], v[48:51], v[176:191]
  s_add_u32 m0, s45, 61440
  ds_read_b64_tr_b16 a[64:65], v12 offset:6144
  ds_read_b64_tr_b16 a[66:67], v12 offset:6656
  buffer_load_dwordx4 v14, s[16:19], s36 offen offset:0 lds
  v_bfe_u32 v147, v0, 1, 3
  v_mfma_f32_32x32x16_bf16 v[192:207], a[72:75], v[48:51], v[192:207]
  ds_read_b64_tr_b16 a[68:69], v13 offset:6144
  ds_read_b64_tr_b16 a[70:71], v13 offset:6656
  v_xor_b32 v147, v147, v128
  v_xor_b32 v148, 0, v147
  v_lshl_add_u32 v228, v148, 4, v146
  v_mfma_f32_32x32x16_bf16 v[208:223], a[76:79], v[48:51], v[208:223]
  ds_read_b64_tr_b16 a[72:73], v12 offset:20480
  ds_read_b64_tr_b16 a[74:75], v12 offset:20992
  v_add_u32 v245, 86016, v228
  v_xor_b32_e64 v148, 2, v147
  v_lshl_add_u32 v229, v148, 4, v146
  v_mfma_f32_32x32x16_bf16 v[160:175], a[80:83], v[52:55], v[160:175]
  ds_read_b64_tr_b16 a[76:77], v13 offset:20480
  ds_read_b64_tr_b16 a[78:79], v13 offset:20992
  s_waitcnt lgkmcnt(6)
  v_add_u32 v246, 86016, v229
  v_xor_b32 v148, 4, v147
  v_mfma_f32_32x32x16_bf16 v[176:191], a[84:87], v[52:55], v[176:191]
  ds_read_b64_tr_b16 a[80:81], v12 offset:8192
  ds_read_b64_tr_b16 a[82:83], v12 offset:8704
  buffer_load_dwordx4 v14, s[16:19], s37 offen offset:1024 lds
  v_lshl_add_u32 v230, v148, 4, v146
  v_add_u32 v247, 86016, v230
  v_mfma_f32_32x32x16_bf16 v[192:207], a[88:91], v[52:55], v[192:207]
  ds_read_b64_tr_b16 a[84:85], v13 offset:8192
  ds_read_b64_tr_b16 a[86:87], v13 offset:8704
  v_xor_b32_e64 v148, 6, v147
  v_lshl_add_u32 v231, v148, 4, v146
  v_add_u32 v248, 86016, v231
  v_mfma_f32_32x32x16_bf16 v[208:223], a[92:95], v[52:55], v[208:223]
  ds_read_b64_tr_b16 a[88:89], v12 offset:22528
  ds_read_b64_tr_b16 a[90:91], v12 offset:23040
  ds_write_b128 v151, v[152:155]
  ds_write_b128 v151, v[152:155] offset:1024
  s_lshl_b32 s60, s6, 2
  v_mfma_f32_32x32x16_bf16 v[160:175], a[64:67], v[56:59], v[160:175]
  ds_read_b64_tr_b16 a[92:93], v13 offset:22528
  ds_read_b64_tr_b16 a[94:95], v13 offset:23040
  s_waitcnt lgkmcnt(8)
  s_waitcnt vmcnt(6)
  ds_read_b64_tr_b16 a[120:121], v142 offset:0
  ds_read_b64_tr_b16 a[122:123], v142 offset:1024
  v_mfma_f32_32x32x16_bf16 v[176:191], a[68:71], v[56:59], v[176:191]
  ds_read_b64_tr_b16 a[64:65], v12 offset:10240
  ds_read_b64_tr_b16 a[66:67], v12 offset:10752
  buffer_load_dwordx4 v14, s[16:19], s38 offen offset:2048 lds
  v_add_u32 v14, 0xffeda700, v14
  ds_read_b64_tr_b16 a[124:125], v143 offset:0
  v_mfma_f32_32x32x16_bf16 v[192:207], a[72:75], v[56:59], v[192:207]
  ds_read_b64_tr_b16 a[68:69], v13 offset:10240
  ds_read_b64_tr_b16 a[70:71], v13 offset:10752
  ds_read_b64_tr_b16 a[126:127], v143 offset:1024
  ds_read_b64_tr_b16 a[128:129], v142 offset:2048
  s_add_u32 s60, s60, s30
  v_mfma_f32_32x32x16_bf16 v[208:223], a[76:79], v[56:59], v[208:223]
  ds_read_b64_tr_b16 a[72:73], v12 offset:24576
  ds_read_b64_tr_b16 a[74:75], v12 offset:25088
  ds_read_b64_tr_b16 a[130:131], v142 offset:3072
  s_mov_b32 s61, 0
  s_mov_b32 s5, 1
  v_mfma_f32_32x32x16_bf16 v[160:175], a[80:83], v[60:63], v[160:175]
  ds_read_b64_tr_b16 a[76:77], v13 offset:24576
  ds_read_b64_tr_b16 a[78:79], v13 offset:25088
  s_waitcnt lgkmcnt(10)
  ds_read_b64_tr_b16 a[132:133], v143 offset:2048
  ds_read_b64_tr_b16 a[134:135], v143 offset:3072
  v_mfma_f32_32x32x16_bf16 v[176:191], a[84:87], v[60:63], v[176:191]
  ds_read_b64_tr_b16 a[80:81], v12 offset:12288
  ds_read_b64_tr_b16 a[82:83], v12 offset:12800
  ds_read_b64_tr_b16 a[136:137], v142 offset:4096
  s_mov_b32 s66, 401408
  s_mov_b32 s67, 0x20000
  v_mfma_f32_32x32x16_bf16 v[192:207], a[88:91], v[60:63], v[192:207]
  ds_read_b64_tr_b16 a[84:85], v13 offset:12288
  ds_read_b64_tr_b16 a[86:87], v13 offset:12800
  ds_read_b64_tr_b16 a[138:139], v142 offset:5120
  ds_read_b64_tr_b16 a[140:141], v143 offset:4096
  s_mov_b32 s98, 401408
  v_mfma_f32_32x32x16_bf16 v[208:223], a[92:95], v[60:63], v[208:223]
  ds_read_b64_tr_b16 a[88:89], v12 offset:26624
  ds_read_b64_tr_b16 a[90:91], v12 offset:27136
  ds_read_b64_tr_b16 a[142:143], v143 offset:5120
  s_mov_b32 s99, 0x20000
  s_mov_b32 s72, s86
  v_mfma_f32_32x32x16_bf16 v[160:175], a[64:67], v[64:67], v[160:175]
  ds_read_b64_tr_b16 a[92:93], v13 offset:26624
  ds_read_b64_tr_b16 a[94:95], v13 offset:27136
  s_waitcnt lgkmcnt(10)
  s_waitcnt lgkmcnt(2)
  s_mov_b32 s73, s87
  v_mfma_f32_32x32x16_bf16 v[176:191], a[68:71], v[64:67], v[176:191]
  s_barrier
  ds_read_b64_tr_b16 a[64:65], v12 offset:28672
  ds_read_b64_tr_b16 a[66:67], v12 offset:29184
  s_mov_b32 s74, 3670016
  s_mov_b32 s75, 0x20000
  v_mfma_f32_32x32x16_bf16 v[192:207], a[72:75], v[64:67], v[192:207]
  s_add_u32 m0, s80, 0
  ds_read_b64_tr_b16 a[68:69], v13 offset:28672
  ds_read_b64_tr_b16 a[70:71], v13 offset:29184
  buffer_load_dwordx4 v224, s[68:71], 0 offen offset:0 lds
  s_add_u32 s76, s20, 11026432
  s_addc_u32 s77, s21, 0
  v_mfma_f32_32x32x16_bf16 v[208:223], a[76:79], v[64:67], v[208:223]
  ds_read_b64_tr_b16 a[72:73], v12 offset:43008
  ds_read_b64_tr_b16 a[74:75], v12 offset:43520
  s_mov_b32 s78, 114688
  s_mov_b32 s79, 0x20000
  s_mul_i32 s51, s31, 168
  v_mfma_f32_32x32x16_bf16 v[160:175], a[80:83], v[68:71], v[160:175]
  ds_read_b64_tr_b16 a[76:77], v13 offset:43008
  ds_read_b64_tr_b16 a[78:79], v13 offset:43520
  s_waitcnt lgkmcnt(6)
  buffer_load_dwordx4 v224, s[68:71], s39 offen offset:1024 lds
  v_add_u32 v224, 14336, v224
  v_mfma_f32_32x32x16_bf16 v[176:191], a[84:87], v[68:71], v[176:191]
  s_add_u32 m0, s42, 86016
  ds_read_b64_tr_b16 a[80:81], v12 offset:30720
  ds_read_b64_tr_b16 a[82:83], v12 offset:31232
  buffer_load_dwordx4 v244, s[12:15], s47 offen offset:0 lds
  s_lshl_b32 s52, s29, 2
  v_mfma_f32_32x32x16_bf16 v[192:207], a[88:91], v[68:71], v[192:207]
  ds_read_b64_tr_b16 a[84:85], v13 offset:30720
  ds_read_b64_tr_b16 a[86:87], v13 offset:31232
  s_add_u32 s52, s51, s52
  s_lshl_b32 s52, s52, 10
  s_lshl_b32 s53, s29, 1
  v_mfma_f32_32x32x16_bf16 v[208:223], a[92:95], v[68:71], v[208:223]
  s_add_u32 m0, s42, 89984
  ds_read_b64_tr_b16 a[88:89], v12 offset:45056
  ds_read_b64_tr_b16 a[90:91], v12 offset:45568
  buffer_load_dwordx4 v244, s[12:15], s47 offen offset:128 lds
  s_add_u32 s53, s51, s53
  v_mfma_f32_32x32x16_bf16 v[160:175], a[64:67], v[72:75], v[160:175]
  ds_read_b64_tr_b16 a[92:93], v13 offset:45056
  ds_read_b64_tr_b16 a[94:95], v13 offset:45568
  s_waitcnt lgkmcnt(6)
  s_add_u32 s53, s53, 112
  s_lshl_b32 s53, s53, 10
  v_mfma_f32_32x32x16_bf16 v[176:191], a[68:71], v[72:75], v[176:191]
  s_add_u32 m0, s42, 93952
  ds_read_b64_tr_b16 a[64:65], v12 offset:32768
  ds_read_b64_tr_b16 a[66:67], v12 offset:33280
  buffer_load_dwordx4 v244, s[12:15], s47 offen offset:256 lds
  s_lshl_b32 s54, s31, 7
  v_mfma_f32_32x32x16_bf16 v[192:207], a[72:75], v[72:75], v[192:207]
  s_add_u32 m0, s80, 2048
  ds_read_b64_tr_b16 a[68:69], v13 offset:32768
  ds_read_b64_tr_b16 a[70:71], v13 offset:33280
  buffer_load_dwordx4 v224, s[68:71], 0 offen offset:0 lds
  s_add_u32 s54, s54, 11141120
  v_mfma_f32_32x32x16_bf16 v[208:223], a[76:79], v[72:75], v[208:223]
  ds_read_b64_tr_b16 a[72:73], v12 offset:47104
  ds_read_b64_tr_b16 a[74:75], v12 offset:47616
  s_mul_i32 s82, s60, 336
  s_mul_i32 s84, s3, 14
  s_add_u32 s83, s82, s84
  v_mfma_f32_32x32x16_bf16 v[160:175], a[80:83], v[76:79], v[160:175]
  ds_read_b64_tr_b16 a[76:77], v13 offset:47104
  ds_read_b64_tr_b16 a[78:79], v13 offset:47616
  s_waitcnt lgkmcnt(6)
  buffer_load_dwordx4 v224, s[68:71], s39 offen offset:1024 lds
  v_add_u32 v224, 14336, v224
  v_mfma_f32_32x32x16_bf16 v[176:191], a[84:87], v[76:79], v[176:191]
  ds_read_b64_tr_b16 a[80:81], v12 offset:34816
  ds_read_b64_tr_b16 a[82:83], v12 offset:35328
  s_lshl_b32 s83, s83, 10
  s_add_u32 s82, s53, 28672
  s_lshl_b32 s85, s60, 8
  v_mfma_f32_32x32x16_bf16 v[192:207], a[88:91], v[76:79], v[192:207]
  s_add_u32 m0, s42, 97920
  ds_read_b64_tr_b16 a[84:85], v13 offset:34816
  ds_read_b64_tr_b16 a[86:87], v13 offset:35328
  buffer_load_dwordx4 v244, s[12:15], s47 offen offset:384 lds
  s_add_u32 s85, s85, 11141120
  v_mfma_f32_32x32x16_bf16 v[208:223], a[92:95], v[76:79], v[208:223]
  ds_read_b64_tr_b16 a[88:89], v12 offset:49152
  ds_read_b64_tr_b16 a[90:91], v12 offset:49664
  s_mul_i32 s86, s7, 57344
  s_add_u32 s87, s86, 28672
  s_mul_i32 s49, s28, 7168
  v_mfma_f32_32x32x16_bf16 v[160:175], a[64:67], v[80:83], v[160:175]
  s_add_u32 m0, s42, 101888
  ds_read_b64_tr_b16 a[92:93], v13 offset:49152
  ds_read_b64_tr_b16 a[94:95], v13 offset:49664
  s_waitcnt lgkmcnt(6)
  buffer_load_dwordx4 v244, s[12:15], s47 offen offset:512 lds
  v_mfma_f32_32x32x16_bf16 v[176:191], a[68:71], v[80:83], v[176:191]
  ds_read_b64_tr_b16 a[64:65], v12 offset:36864
  ds_read_b64_tr_b16 a[66:67], v12 offset:37376
  s_lshl_b32 s50, s29, 9
  s_add_u32 s49, s49, s50
  v_mfma_f32_32x32x16_bf16 v[192:207], a[72:75], v[80:83], v[192:207]
  s_add_u32 m0, s80, 4096
  ds_read_b64_tr_b16 a[68:69], v13 offset:36864
  ds_read_b64_tr_b16 a[70:71], v13 offset:37376
  buffer_load_dwordx4 v224, s[68:71], 0 offen offset:0 lds
  v_mfma_f32_32x32x16_bf16 v[208:223], a[76:79], v[80:83], v[208:223]
  ds_read_b64_tr_b16 a[72:73], v12 offset:51200
  ds_read_b64_tr_b16 a[74:75], v12 offset:51712
  v_mfma_f32_32x32x16_bf16 v[160:175], a[80:83], v[84:87], v[160:175]
  ds_read_b64_tr_b16 a[76:77], v13 offset:51200
  ds_read_b64_tr_b16 a[78:79], v13 offset:51712
  s_waitcnt lgkmcnt(6)
  buffer_load_dwordx4 v224, s[68:71], s39 offen offset:1024 lds
  v_add_u32 v224, 14336, v224
  v_mfma_f32_32x32x16_bf16 v[176:191], a[84:87], v[84:87], v[176:191]
  s_add_u32 m0, s42, 105856
  ds_read_b64_tr_b16 a[80:81], v12 offset:38912
  ds_read_b64_tr_b16 a[82:83], v12 offset:39424
  buffer_load_dwordx4 v244, s[12:15], s47 offen offset:640 lds
  v_mfma_f32_32x32x16_bf16 v[192:207], a[88:91], v[84:87], v[192:207]
  ds_read_b64_tr_b16 a[84:85], v13 offset:38912
  ds_read_b64_tr_b16 a[86:87], v13 offset:39424
  v_mfma_f32_32x32x16_bf16 v[208:223], a[92:95], v[84:87], v[208:223]
  s_add_u32 m0, s42, 109824
  ds_read_b64_tr_b16 a[88:89], v12 offset:53248
  ds_read_b64_tr_b16 a[90:91], v12 offset:53760
  buffer_load_dwordx4 v244, s[12:15], s47 offen offset:768 lds
  v_mfma_f32_32x32x16_bf16 v[160:175], a[64:67], v[88:91], v[160:175]
  ds_read_b64_tr_b16 a[92:93], v13 offset:53248
  ds_read_b64_tr_b16 a[94:95], v13 offset:53760
  s_waitcnt lgkmcnt(6)
  v_mfma_f32_32x32x16_bf16 v[176:191], a[68:71], v[88:91], v[176:191]
  ds_read_b64_tr_b16 a[64:65], v12 offset:40960
  ds_read_b64_tr_b16 a[66:67], v12 offset:41472
  v_mfma_f32_32x32x16_bf16 v[192:207], a[72:75], v[88:91], v[192:207]
  s_add_u32 m0, s80, 6144
  ds_read_b64_tr_b16 a[68:69], v13 offset:40960
  ds_read_b64_tr_b16 a[70:71], v13 offset:41472
  buffer_load_dwordx4 v224, s[68:71], 0 offen offset:0 lds
  v_mfma_f32_32x32x16_bf16 v[208:223], a[76:79], v[88:91], v[208:223]
  ds_read_b64_tr_b16 a[72:73], v12 offset:55296
  ds_read_b64_tr_b16 a[74:75], v12 offset:55808
  v_mfma_f32_32x32x16_bf16 v[160:175], a[80:83], v[92:95], v[160:175]
  ds_read_b64_tr_b16 a[76:77], v13 offset:55296
  ds_read_b64_tr_b16 a[78:79], v13 offset:55808
  s_waitcnt lgkmcnt(6)
  buffer_load_dwordx4 v224, s[68:71], s39 offen offset:1024 lds
  v_add_u32 v224, 14336, v224
  v_mfma_f32_32x32x16_bf16 v[176:191], a[84:87], v[92:95], v[176:191]
  s_waitcnt vmcnt(15)
  s_barrier
  ds_read_b64_tr_b16 a[80:81], v252 offset:0
  ds_read_b64_tr_b16 a[82:83], v252 offset:512
  v_mfma_f32_32x32x16_bf16 v[192:207], a[88:91], v[92:95], v[192:207]
  s_add_u32 m0, s42, 0
  ds_read_b64_tr_b16 a[84:85], v253 offset:0
  ds_read_b64_tr_b16 a[86:87], v253 offset:512
  buffer_load_dwordx4 v244, s[92:95], s47 offen offset:0 lds
  v_mfma_f32_32x32x16_bf16 v[208:223], a[92:95], v[92:95], v[208:223]
  ds_read_b64_tr_b16 a[88:89], v252 offset:14336
  ds_read_b64_tr_b16 a[90:91], v252 offset:14848
  v_mfma_f32_32x32x16_bf16 v[160:175], a[64:67], v[96:99], v[160:175]
  s_add_u32 m0, s42, 3968
  ds_read_b64_tr_b16 a[92:93], v253 offset:14336
  ds_read_b64_tr_b16 a[94:95], v253 offset:14848
  s_waitcnt lgkmcnt(6)
  buffer_load_dwordx4 v244, s[92:95], s47 offen offset:128 lds
  v_mfma_f32_32x32x16_bf16 v[176:191], a[68:71], v[96:99], v[176:191]
  ds_read_b64_tr_b16 a[64:65], v252 offset:2048
  ds_read_b64_tr_b16 a[66:67], v252 offset:2560
  v_mfma_f32_32x32x16_bf16 v[192:207], a[72:75], v[96:99], v[192:207]
  s_add_u32 m0, s80, 8192
  ds_read_b64_tr_b16 a[68:69], v253 offset:2048
  ds_read_b64_tr_b16 a[70:71], v253 offset:2560
  buffer_load_dwordx4 v224, s[68:71], 0 offen offset:0 lds
  v_mfma_f32_32x32x16_bf16 v[208:223], a[76:79], v[96:99], v[208:223]
  ds_read_b64_tr_b16 a[72:73], v252 offset:16384
  ds_read_b64_tr_b16 a[74:75], v252 offset:16896
  v_mfma_f32_32x32x16_bf16 v[160:175], a[80:83], v[100:103], v[160:175]
  ds_read_b64_tr_b16 a[76:77], v253 offset:16384
  ds_read_b64_tr_b16 a[78:79], v253 offset:16896
  s_waitcnt lgkmcnt(6)
  buffer_load_dwordx4 v224, s[68:71], s39 offen offset:1024 lds
  v_add_u32 v224, 14336, v224
  v_mfma_f32_32x32x16_bf16 v[176:191], a[84:87], v[100:103], v[176:191]
  s_add_u32 m0, s42, 7936
  ds_read_b64_tr_b16 a[80:81], v252 offset:4096
  ds_read_b64_tr_b16 a[82:83], v252 offset:4608
  s_waitcnt vmcnt(17)
  ds_read_b64_tr_b16 a[144:145], v225 offset:0
  buffer_load_dwordx4 v244, s[92:95], s47 offen offset:256 lds
  v_mfma_f32_32x32x16_bf16 v[192:207], a[88:91], v[100:103], v[192:207]
  ds_read_b64_tr_b16 a[84:85], v253 offset:4096
  ds_read_b64_tr_b16 a[86:87], v253 offset:4608
  ds_read_b64_tr_b16 a[146:147], v225 offset:1024
  v_mfma_f32_32x32x16_bf16 v[208:223], a[92:95], v[100:103], v[208:223]
  s_add_u32 m0, s42, 11904
  ds_read_b64_tr_b16 a[88:89], v252 offset:18432
  ds_read_b64_tr_b16 a[90:91], v252 offset:18944
  ds_read_b64_tr_b16 a[148:149], v226 offset:0
  buffer_load_dwordx4 v244, s[92:95], s47 offen offset:384 lds
  v_mfma_f32_32x32x16_bf16 v[160:175], a[64:67], v[104:107], v[160:175]
  ds_read_b64_tr_b16 a[92:93], v253 offset:18432
  ds_read_b64_tr_b16 a[94:95], v253 offset:18944
  s_waitcnt lgkmcnt(9)
  ds_read_b64_tr_b16 a[150:151], v226 offset:1024
  v_mfma_f32_32x32x16_bf16 v[176:191], a[68:71], v[104:107], v[176:191]
  s_add_u32 m0, s42, 15872
  ds_read_b64_tr_b16 a[64:65], v252 offset:6144
  ds_read_b64_tr_b16 a[66:67], v252 offset:6656
  s_waitcnt lgkmcnt(2)
  buffer_load_dwordx4 v244, s[92:95], s47 offen offset:512 lds
  v_mfma_f32_32x32x16_bf16 v[192:207], a[72:75], v[104:107], v[192:207]
  s_add_u32 m0, s80, 0
  ds_read_b64_tr_b16 a[68:69], v253 offset:6144
  ds_read_b64_tr_b16 a[70:71], v253 offset:6656
  buffer_load_dwordx4 v224, s[68:71], 0 offen offset:0 lds
  v_mfma_f32_32x32x16_bf16 v[208:223], a[76:79], v[104:107], v[208:223]
  ds_read_b64_tr_b16 a[72:73], v252 offset:20480
  ds_read_b64_tr_b16 a[74:75], v252 offset:20992
  v_mfma_f32_32x32x16_bf16 v[160:175], a[80:83], v[108:111], v[160:175]
  ds_read_b64_tr_b16 a[76:77], v253 offset:20480
  ds_read_b64_tr_b16 a[78:79], v253 offset:20992
  s_waitcnt lgkmcnt(6)
  buffer_load_dwordx4 v224, s[68:71], s39 offen offset:1024 lds
  v_add_u32 v224, 14336, v224
  v_mfma_f32_32x32x16_bf16 v[176:191], a[84:87], v[108:111], v[176:191]
  ds_read_b64_tr_b16 a[80:81], v252 offset:8192
  ds_read_b64_tr_b16 a[82:83], v252 offset:8704
  s_waitcnt vmcnt(17)
  ds_read_b64_tr_b16 a[152:153], v225 offset:2048
  v_mfma_f32_32x32x16_bf16 v[192:207], a[88:91], v[108:111], v[192:207]
  s_add_u32 m0, s42, 19840
  ds_read_b64_tr_b16 a[84:85], v253 offset:8192
  ds_read_b64_tr_b16 a[86:87], v253 offset:8704
  ds_read_b64_tr_b16 a[154:155], v225 offset:3072
  buffer_load_dwordx4 v244, s[92:95], s47 offen offset:640 lds
  v_mfma_f32_32x32x16_bf16 v[208:223], a[92:95], v[108:111], v[208:223]
  ds_read_b64_tr_b16 a[88:89], v252 offset:22528
  ds_read_b64_tr_b16 a[90:91], v252 offset:23040
  ds_read_b64_tr_b16 a[156:157], v226 offset:2048
  v_mfma_f32_32x32x16_bf16 v[160:175], a[64:67], v[112:115], v[160:175]
  s_add_u32 m0, s42, 23808
  ds_read_b64_tr_b16 a[92:93], v253 offset:22528
  ds_read_b64_tr_b16 a[94:95], v253 offset:23040
  s_waitcnt lgkmcnt(9)
  ds_read_b64_tr_b16 a[158:159], v226 offset:3072
  buffer_load_dwordx4 v244, s[92:95], s47 offen offset:768 lds
  v_mfma_f32_32x32x16_bf16 v[176:191], a[68:71], v[112:115], v[176:191]
  ds_read_b64_tr_b16 a[64:65], v252 offset:10240
  ds_read_b64_tr_b16 a[66:67], v252 offset:10752
  s_waitcnt lgkmcnt(2)
  v_mfma_f32_32x32x16_bf16 v[192:207], a[72:75], v[112:115], v[192:207]
  s_add_u32 m0, s80, 2048
  ds_read_b64_tr_b16 a[68:69], v253 offset:10240
  ds_read_b64_tr_b16 a[70:71], v253 offset:10752
  buffer_load_dwordx4 v224, s[68:71], 0 offen offset:0 lds
  v_mfma_f32_32x32x16_bf16 v[208:223], a[76:79], v[112:115], v[208:223]
  ds_read_b64_tr_b16 a[72:73], v252 offset:24576
  ds_read_b64_tr_b16 a[74:75], v252 offset:25088
  v_mfma_f32_32x32x16_bf16 v[160:175], a[80:83], v[116:119], v[160:175]
  ds_read_b64_tr_b16 a[76:77], v253 offset:24576
  ds_read_b64_tr_b16 a[78:79], v253 offset:25088
  s_waitcnt lgkmcnt(6)
  buffer_load_dwordx4 v224, s[68:71], s39 offen offset:1024 lds
  v_add_u32 v224, 14336, v224
  v_mfma_f32_32x32x16_bf16 v[176:191], a[84:87], v[116:119], v[176:191]
  ds_read_b64_tr_b16 a[80:81], v252 offset:12288
  ds_read_b64_tr_b16 a[82:83], v252 offset:12800
  s_waitcnt vmcnt(17)
  ds_read_b64_tr_b16 a[160:161], v225 offset:4096
  v_mfma_f32_32x32x16_bf16 v[192:207], a[88:91], v[116:119], v[192:207]
  ds_read_b64_tr_b16 a[84:85], v253 offset:12288
  ds_read_b64_tr_b16 a[86:87], v253 offset:12800
  ds_read_b64_tr_b16 a[162:163], v225 offset:5120
  v_mfma_f32_32x32x16_bf16 v[208:223], a[92:95], v[116:119], v[208:223]
  ds_read_b64_tr_b16 a[88:89], v252 offset:26624
  ds_read_b64_tr_b16 a[90:91], v252 offset:27136
  ds_read_b64_tr_b16 a[164:165], v226 offset:4096
  v_mfma_f32_32x32x16_bf16 v[160:175], a[64:67], v[120:123], v[160:175]
  ds_read_b64_tr_b16 a[92:93], v253 offset:26624
  ds_read_b64_tr_b16 a[94:95], v253 offset:27136
  s_waitcnt lgkmcnt(9)
  ds_read_b64_tr_b16 a[166:167], v226 offset:5120
  v_mfma_f32_32x32x16_bf16 v[176:191], a[68:71], v[120:123], v[176:191]
  s_waitcnt vmcnt(15)
  s_barrier
  ds_read_b128 a[64:67], v245 offset:0
  s_waitcnt lgkmcnt(1)
  v_mfma_f32_32x32x16_bf16 v[192:207], a[72:75], v[120:123], v[192:207]
  s_add_u32 m0, s80, 4096
  ds_read_b128 a[68:71], v246 offset:0
  buffer_load_dwordx4 v224, s[68:71], 0 offen offset:0 lds
  v_mfma_f32_32x32x16_bf16 v[208:223], a[76:79], v[120:123], v[208:223]
  ds_read_b128 a[72:75], v247 offset:0
  v_mfma_f32_32x32x16_bf16 v[160:175], a[80:83], v[124:127], v[160:175]
  ds_read_b128 a[76:79], v248 offset:0
  s_waitcnt lgkmcnt(3)
  buffer_load_dwordx4 v224, s[68:71], s39 offen offset:1024 lds
  v_add_u32 v224, 616448, v224
  v_mfma_f32_32x32x16_bf16 v[176:191], a[84:87], v[124:127], v[176:191]
  s_add_u32 m0, s45, 28672
  ds_read_b128 a[80:83], v245 offset:4096
  s_waitcnt vmcnt(15)
  ds_read_b64_tr_b16 a[168:169], v225 offset:6144
  buffer_load_dwordx4 v14, s[16:19], 0 offen offset:0 lds
  v_mfma_f32_32x32x16_bf16 v[192:207], a[88:91], v[124:127], v[192:207]
  ds_read_b128 a[84:87], v246 offset:4096
  ds_read_b64_tr_b16 a[170:171], v225 offset:7168
  v_mfma_f32_32x32x16_bf16 v[208:223], a[92:95], v[124:127], v[208:223]
  ds_read_b128 a[88:91], v247 offset:4096
  ds_read_b64_tr_b16 a[172:173], v226 offset:6144
  buffer_load_dwordx4 v14, s[16:19], s33 offen offset:1024 lds
  v_mfma_f32_32x32x16_bf16 v[128:143], v[16:19], a[64:67], 0
  ds_read_b128 a[92:95], v248 offset:4096
  s_waitcnt lgkmcnt(6)
  ds_read_b64_tr_b16 a[174:175], v226 offset:7168
  v_mfma_f32_32x32x16_bf16 v[128:143], v[20:23], a[68:71], v[128:143]
  ds_read_b128 a[64:67], v245 offset:8192
  s_waitcnt lgkmcnt(1)
  buffer_load_dwordx4 v14, s[16:19], s34 offen offset:2048 lds
  v_mfma_f32_32x32x16_bf16 v[128:143], v[24:27], a[72:75], v[128:143]
  s_add_u32 m0, s80, 6144
  ds_read_b128 a[68:71], v246 offset:8192
  buffer_load_dwordx4 v224, s[68:71], 0 offen offset:0 lds
  v_mul_f32 v160, v160, v192
  v_mul_f32_e64 v161, v161, v193
  v_cvt_pk_bf16_f32 v192, v160, v161
  v_mfma_f32_32x32x16_bf16 v[128:143], v[28:31], a[76:79], v[128:143]
  ds_read_b128 a[72:75], v247 offset:8192
  v_mul_f32 v162, v162, v194
  v_mul_f32 v163, v163, v195
  v_cvt_pk_bf16_f32 v193, v162, v163
  v_mul_f32 v164, v164, v196
  v_mul_f32 v165, v165, v197
  v_mfma_f32_32x32x16_bf16 v[128:143], v[32:35], a[80:83], v[128:143]
  ds_read_b128 a[76:79], v248 offset:8192
  s_waitcnt lgkmcnt(3)
  buffer_load_dwordx4 v224, s[68:71], s39 offen offset:1024 lds
  v_add_u32 v224, 14336, v224
  v_cvt_pk_bf16_f32 v194, v164, v165
  v_mul_f32 v166, v166, v198
  v_mfma_f32_32x32x16_bf16 v[128:143], v[36:39], a[84:87], v[128:143]
  ds_read_b128 a[80:83], v245 offset:12288
  s_waitcnt vmcnt(16)
  ds_read_b64_tr_b16 a[176:177], v225 offset:8192
  v_mul_f32 v167, v167, v199
  v_cvt_pk_bf16_f32 v195, v166, v167
  v_mul_f32_e64 v168, v168, v200
  v_mfma_f32_32x32x16_bf16 v[128:143], v[40:43], a[88:91], v[128:143]
  s_add_u32 m0, s45, 28672
  ds_read_b128 a[84:87], v246 offset:12288
  ds_read_b64_tr_b16 a[178:179], v225 offset:9216
  buffer_load_dwordx4 v14, s[16:19], s35 offen offset:3072 lds
  v_mul_f32_e64 v169, v169, v201
  v_mfma_f32_32x32x16_bf16 v[128:143], v[44:47], a[92:95], v[128:143]
  ds_read_b128 a[88:91], v247 offset:12288
  ds_read_b64_tr_b16 a[180:181], v226 offset:8192
  v_cvt_pk_bf16_f32 v196, v168, v169
  v_mul_f32 v170, v170, v202
  v_mul_f32 v171, v171, v203
  v_mfma_f32_32x32x16_bf16 v[128:143], v[48:51], a[64:67], v[128:143]
  s_add_u32 m0, s45, 32768
  ds_read_b128 a[92:95], v248 offset:12288
  s_waitcnt lgkmcnt(6)
  ds_read_b64_tr_b16 a[182:183], v226 offset:9216
  buffer_load_dwordx4 v14, s[16:19], s36 offen offset:0 lds
  buffer_store_dwordx4 v[192:195], v1, s[20:23], s52 offen offset:0 sc1
  v_mfma_f32_32x32x16_bf16 v[128:143], v[52:55], a[68:71], v[128:143]
  ds_read_b128 a[64:67], v245 offset:16384
  s_waitcnt lgkmcnt(1)
  v_cvt_pk_bf16_f32 v197, v170, v171
  v_mul_f32 v172, v172, v204
  v_mul_f32 v173, v173, v205
  v_mfma_f32_32x32x16_bf16 v[128:143], v[56:59], a[72:75], v[128:143]
  s_add_u32 m0, s80, 8192
  ds_read_b128 a[68:71], v246 offset:16384
  buffer_load_dwordx4 v224, s[68:71], 0 offen offset:0 lds
  v_cvt_pk_bf16_f32 v198, v172, v173
  v_mul_f32_e64 v174, v174, v206
  v_mfma_f32_32x32x16_bf16 v[128:143], v[60:63], a[76:79], v[128:143]
  ds_read_b128 a[72:75], v247 offset:16384
  v_mul_f32_e64 v175, v175, v207
  v_cvt_pk_bf16_f32 v199, v174, v175
  v_mul_f32 v176, v176, v208
  v_mul_f32 v177, v177, v209
  v_mfma_f32_32x32x16_bf16 v[128:143], v[64:67], a[80:83], v[128:143]
  ds_read_b128 a[76:79], v248 offset:16384
  s_waitcnt lgkmcnt(3)
  buffer_load_dwordx4 v224, s[68:71], s39 offen offset:1024 lds
  v_add_u32 v224, 14336, v224
  v_cvt_pk_bf16_f32 v208, v176, v177
  v_mfma_f32_32x32x16_bf16 v[128:143], v[68:71], a[84:87], v[128:143]
  s_add_u32 m0, s45, 32768
  ds_read_b128 a[80:83], v245 offset:20480
  s_waitcnt vmcnt(16)
  ds_read_b64_tr_b16 a[184:185], v225 offset:0
  buffer_load_dwordx4 v14, s[16:19], s37 offen offset:1024 lds
  v_mfma_f32_32x32x16_bf16 v[128:143], v[72:75], a[88:91], v[128:143]
  ds_read_b128 a[84:87], v246 offset:20480
  ds_read_b64_tr_b16 a[186:187], v225 offset:1024
  buffer_store_dwordx4 v[196:199], v1, s[20:23], s52 offen offset:1024 sc1
  v_mul_f32 v178, v178, v210
  v_mul_f32 v179, v179, v211
  v_mfma_f32_32x32x16_bf16 v[128:143], v[76:79], a[92:95], v[128:143]
  ds_read_b128 a[88:91], v247 offset:20480
  ds_read_b64_tr_b16 a[188:189], v226 offset:0
  buffer_load_dwordx4 v14, s[16:19], s38 offen offset:2048 lds
  v_add_u32 v14, 0x62000, v14
  v_cvt_pk_bf16_f32 v209, v178, v179
  v_mfma_f32_32x32x16_bf16 v[128:143], v[80:83], a[64:67], v[128:143]
  ds_read_b128 a[92:95], v248 offset:20480
  s_waitcnt lgkmcnt(6)
  ds_read_b64_tr_b16 a[190:191], v226 offset:1024
  v_mul_f32 v180, v180, v212
  v_mul_f32_e64 v181, v181, v213
  v_mfma_f32_32x32x16_bf16 v[128:143], v[84:87], a[68:71], v[128:143]
  ds_read_b128 a[64:67], v245 offset:24576
  s_waitcnt lgkmcnt(1)
  v_cvt_pk_bf16_f32 v210, v180, v181
  v_mul_f32 v182, v182, v214
  v_mul_f32_e64 v183, v183, v215
  v_mfma_f32_32x32x16_bf16 v[128:143], v[88:91], a[72:75], v[128:143]
  s_add_u32 m0, s80, 0
  ds_read_b128 a[68:71], v246 offset:24576
  buffer_load_dwordx4 v224, s[68:71], 0 offen offset:0 lds
  v_cvt_pk_bf16_f32 v211, v182, v183
  v_mul_f32 v184, v184, v216
  v_mfma_f32_32x32x16_bf16 v[128:143], v[92:95], a[76:79], v[128:143]
  ds_read_b128 a[72:75], v247 offset:24576
  v_mul_f32_e64 v185, v185, v217
  v_cvt_pk_bf16_f32 v212, v184, v185
  v_mul_f32 v186, v186, v218
  v_mul_f32 v187, v187, v219
  v_mfma_f32_32x32x16_bf16 v[128:143], v[96:99], a[80:83], v[128:143]
  ds_read_b128 a[76:79], v248 offset:24576
  s_waitcnt lgkmcnt(3)
  buffer_load_dwordx4 v224, s[68:71], s39 offen offset:1024 lds
  v_add_u32 v224, 14336, v224
  buffer_store_dwordx4 v[208:211], v1, s[20:23], s52 offen offset:2048 sc1
  v_mfma_f32_32x32x16_bf16 v[128:143], v[100:103], a[84:87], v[128:143]
  s_waitcnt vmcnt(20)
  s_barrier
  ds_read_b128 a[80:83], v228 offset:0
  s_waitcnt vmcnt(18)
  ds_read_b64_tr_b16 a[192:193], v225 offset:2048
  v_mfma_f32_32x32x16_bf16 v[128:143], v[104:107], a[88:91], v[128:143]
  s_add_u32 m0, s45, 57344
  ds_read_b128 a[84:87], v229 offset:0
  ds_read_b64_tr_b16 a[194:195], v225 offset:3072
  buffer_load_dwordx4 v14, s[16:19], 0 offen offset:0 lds
  v_cvt_pk_bf16_f32 v213, v186, v187
  v_mfma_f32_32x32x16_bf16 v[128:143], v[108:111], a[92:95], v[128:143]
  ds_read_b128 a[88:91], v230 offset:0
  ds_read_b64_tr_b16 a[196:197], v226 offset:2048
  v_mul_f32 v188, v188, v220
  v_mul_f32 v189, v189, v221
  v_cvt_pk_bf16_f32 v214, v188, v189
  v_mfma_f32_32x32x16_bf16 v[128:143], v[112:115], a[64:67], v[128:143]
  ds_read_b128 a[92:95], v231 offset:0
  s_waitcnt lgkmcnt(6)
  ds_read_b64_tr_b16 a[198:199], v226 offset:3072
  buffer_load_dwordx4 v14, s[16:19], s33 offen offset:1024 lds
  v_mul_f32 v190, v190, v222
  v_mfma_f32_32x32x16_bf16 v[128:143], v[116:119], a[68:71], v[128:143]
  ds_read_b128 a[64:67], v228 offset:4096
  s_waitcnt lgkmcnt(1)
  v_mul_f32 v191, v191, v223
  v_cvt_pk_bf16_f32 v215, v190, v191
  v_mfma_f32_32x32x16_bf16 v[128:143], v[120:123], a[72:75], v[128:143]
  s_add_u32 m0, s80, 2048
  ds_read_b128 a[68:71], v229 offset:4096
  buffer_load_dwordx4 v224, s[68:71], 0 offen offset:0 lds
  buffer_store_dwordx4 v[212:215], v1, s[20:23], s52 offen offset:3072 sc1
  v_mfma_f32_32x32x16_bf16 v[128:143], v[124:127], a[76:79], v[128:143]
  ds_read_b128 a[72:75], v230 offset:4096
  v_mfma_f32_32x32x16_bf16 v[144:159], v[16:19], a[80:83], 0
  ds_read_b128 a[76:79], v231 offset:4096
  s_waitcnt lgkmcnt(3)
  buffer_load_dwordx4 v224, s[68:71], s39 offen offset:1024 lds
  v_add_u32 v224, 14336, v224
  ds_read_b128 v[176:179], v251 offset:0
  v_mfma_f32_32x32x16_bf16 v[144:159], v[20:23], a[84:87], v[144:159]
  s_add_u32 m0, s45, 57344
  ds_read_b128 a[80:83], v228 offset:8192
  s_waitcnt vmcnt(21)
  ds_read_b64_tr_b16 a[200:201], v225 offset:4096
  buffer_load_dwordx4 v14, s[16:19], s34 offen offset:2048 lds
  ds_read_b128 v[180:183], v251 offset:16
  v_mfma_f32_32x32x16_bf16 v[144:159], v[24:27], a[88:91], v[144:159]
  ds_read_b128 a[84:87], v229 offset:8192
  ds_read_b64_tr_b16 a[202:203], v225 offset:5120
  ds_read_b128 v[184:187], v251 offset:32
  v_readfirstlane_b32 s58, v227
  s_nop 1
  s_cmp_eq_u32 s58, 0
  s_cbranch_scc1 L_nonce_spin
L_nonce_ok:
  v_mfma_f32_32x32x16_bf16 v[144:159], v[28:31], a[92:95], v[144:159]
  ds_read_b128 a[88:91], v230 offset:8192
  ds_read_b64_tr_b16 a[204:205], v226 offset:4096
  buffer_load_dwordx4 v14, s[16:19], s35 offen offset:3072 lds
  ds_read_b128 v[188:191], v251 offset:48
  s_add_u32 s52, s52, 57344
  v_mfma_f32_32x32x16_bf16 v[144:159], v[32:35], a[64:67], v[144:159]
  ds_read_b128 a[92:95], v231 offset:8192
  s_waitcnt lgkmcnt(9)
  ds_read_b64_tr_b16 a[206:207], v226 offset:5120
  v_mul_f32 v170, v5, v5
  v_mul_f32_e64 v171, v4, v5
  v_mfma_f32_32x32x16_bf16 v[144:159], v[36:39], a[68:71], v[144:159]
  s_add_u32 m0, s45, 61440
  ds_read_b128 a[64:67], v228 offset:12288
  s_waitcnt lgkmcnt(1)
  buffer_load_dwordx4 v14, s[16:19], s36 offen offset:0 lds
  v_fma_f32 v160, v4, v4, -v170
  v_mfma_f32_32x32x16_bf16 v[144:159], v[40:43], a[72:75], v[144:159]
  s_add_u32 m0, s80, 4096
  ds_read_b128 a[68:71], v229 offset:12288
  buffer_load_dwordx4 v224, s[68:71], 0 offen offset:0 lds
  v_add_f32 v161, v171, v171
  v_mul_f32_e64 v170, v161, v161
  v_mfma_f32_32x32x16_bf16 v[144:159], v[44:47], a[76:79], v[144:159]
  ds_read_b128 a[72:75], v230 offset:12288
  v_mul_f32_e64 v171, v160, v161
  v_fma_f32 v162, v160, v160, -v170
  v_add_f32 v163, v171, v171
  v_mul_f32 v170, v11, v5
  v_mfma_f32_32x32x16_bf16 v[144:159], v[48:51], a[80:83], v[144:159]
  ds_read_b128 a[76:79], v231 offset:12288
  s_waitcnt lgkmcnt(3)
  buffer_load_dwordx4 v224, s[68:71], s39 offen offset:1024 lds
  v_add_u32 v224, 14336, v224
  v_mul_f32 v171, v11, v4
  v_mfma_f32_32x32x16_bf16 v[144:159], v[52:55], a[84:87], v[144:159]
  ds_read_b128 a[80:83], v228 offset:16384
  s_waitcnt vmcnt(21)
  ds_read_b64_tr_b16 a[208:209], v225 offset:6144
  v_fma_f32 v165, v10, v5, v171
  v_fma_f32 v164, v10, v4, -v170
  v_mfma_f32_32x32x16_bf16 v[144:159], v[56:59], a[88:91], v[144:159]
  s_add_u32 m0, s45, 61440
  ds_read_b128 a[84:87], v229 offset:16384
  ds_read_b64_tr_b16 a[210:211], v225 offset:7168
  buffer_load_dwordx4 v14, s[16:19], s37 offen offset:1024 lds
  s_mov_b32 s90, 0
  v_mfma_f32_32x32x16_bf16 v[144:159], v[60:63], a[92:95], v[144:159]
  ds_read_b128 a[88:91], v230 offset:16384
  ds_read_b64_tr_b16 a[212:213], v226 offset:6144
  s_mov_b32 s91, -1
  v_cndmask_b32 v164, v10, v164, s[90:91]
  v_cndmask_b32 v165, v11, v165, s[90:91]
  v_mfma_f32_32x32x16_bf16 v[144:159], v[64:67], a[64:67], v[144:159]
  ds_read_b128 a[92:95], v231 offset:16384
  s_waitcnt lgkmcnt(6)
  ds_read_b64_tr_b16 a[214:215], v226 offset:7168
  buffer_load_dwordx4 v14, s[16:19], s38 offen offset:2048 lds
  v_add_u32 v14, 0x62000, v14
  v_mfma_f32_32x32x16_bf16 v[144:159], v[68:71], a[68:71], v[144:159]
  ds_read_b128 a[64:67], v228 offset:20480
  s_waitcnt lgkmcnt(1)
  v_mul_f32 v170, v165, v161
  v_mul_f32_e64 v171, v165, v160
  v_fma_f32 v167, v164, v161, v171
  v_mfma_f32_32x32x16_bf16 v[144:159], v[72:75], a[72:75], v[144:159]
  s_add_u32 m0, s80, 6144
  ds_read_b128 a[68:71], v229 offset:20480
  buffer_load_dwordx4 v224, s[68:71], 0 offen offset:0 lds
  v_fma_f32 v166, v164, v160, -v170
  s_cmp_eq_u32 s46, 1
  s_cselect_b64 s[90:91], -1, 0
  v_mfma_f32_32x32x16_bf16 v[144:159], v[76:79], a[76:79], v[144:159]
  ds_read_b128 a[72:75], v230 offset:20480
  v_cndmask_b32 v164, v164, v166, s[90:91]
  v_cndmask_b32 v165, v165, v167, s[90:91]
  v_mul_f32 v170, v165, v163
  v_mul_f32 v171, v165, v162
  v_mfma_f32_32x32x16_bf16 v[144:159], v[80:83], a[80:83], v[144:159]
  ds_read_b128 a[76:79], v231 offset:20480
  s_waitcnt lgkmcnt(3)
  buffer_load_dwordx4 v224, s[68:71], s39 offen offset:1024 lds
  v_add_u32 v224, 14336, v224
  v_fma_f32 v167, v164, v163, v171
  v_mfma_f32_32x32x16_bf16 v[144:159], v[84:87], a[84:87], v[144:159]
  ds_read_b128 a[80:83], v228 offset:24576
  s_waitcnt vmcnt(20)
  ds_read_b64_tr_b16 a[216:217], v225 offset:8192
  v_fma_f32 v166, v164, v162, -v170
  s_cmp_ge_u32 s3, 2
  s_cselect_b64 s[90:91], -1, 0
  v_mfma_f32_32x32x16_bf16 v[144:159], v[88:91], a[88:91], v[144:159]
  ds_read_b128 a[84:87], v229 offset:24576
  ds_read_b64_tr_b16 a[218:219], v225 offset:9216
  v_cndmask_b32 v15, v164, v166, s[90:91]
  v_mul_f32 v128, v176, v128
  v_mul_f32 v129, v177, v129
  v_mfma_f32_32x32x16_bf16 v[144:159], v[92:95], a[92:95], v[144:159]
  ds_read_b128 a[88:91], v230 offset:24576
  ds_read_b64_tr_b16 a[220:221], v226 offset:8192
  v_mul_f32_e64 v130, v178, v130
  v_mul_f32 v131, v179, v131
  v_mul_f32 v132, v180, v132
  v_mfma_f32_32x32x16_bf16 v[144:159], v[96:99], a[64:67], v[144:159]
  ds_read_b128 a[92:95], v231 offset:24576
  s_waitcnt lgkmcnt(6)
  ds_read_b64_tr_b16 a[222:223], v226 offset:9216
  v_mul_f32 v133, v181, v133
  v_mul_f32_e64 v134, v182, v134
  v_mfma_f32_32x32x16_bf16 v[144:159], v[100:103], a[68:71], v[144:159]
  s_waitcnt vmcnt(17)
  s_barrier
  ds_read_b64_tr_b16 a[64:65], v12 offset:28672
  ds_read_b64_tr_b16 a[66:67], v12 offset:29184
  s_waitcnt lgkmcnt(2)
  v_mfma_f32_32x32x16_bf16 v[144:159], v[104:107], a[72:75], v[144:159]
  s_add_u32 m0, s80, 8192
  ds_read_b64_tr_b16 a[68:69], v13 offset:28672
  ds_read_b64_tr_b16 a[70:71], v13 offset:29184
  buffer_load_dwordx4 v224, s[68:71], 0 offen offset:0 lds
  ds_read_b128 v[228:231], v251 offset:0
  v_mfma_f32_32x32x16_bf16 v[144:159], v[108:111], a[76:79], v[144:159]
  ds_read_b64_tr_b16 a[72:73], v12 offset:43008
  ds_read_b64_tr_b16 a[74:75], v12 offset:43520
  ds_read_b128 v[232:235], v251 offset:16
  v_mul_f32 v135, v183, v135
  v_mul_f32_e64 v136, v184, v136
  v_mfma_f32_32x32x16_bf16 v[144:159], v[112:115], a[80:83], v[144:159]
  ds_read_b64_tr_b16 a[76:77], v13 offset:43008
  ds_read_b64_tr_b16 a[78:79], v13 offset:43520
  s_waitcnt lgkmcnt(8)
  buffer_load_dwordx4 v224, s[68:71], s39 offen offset:1024 lds
  v_add_u32 v224, 14336, v224
  ds_read_b128 v[236:239], v251 offset:32
  v_mfma_f32_32x32x16_bf16 v[144:159], v[116:119], a[84:87], v[144:159]
  s_add_u32 m0, s45, 86016
  ds_read_b64_tr_b16 a[80:81], v12 offset:30720
  ds_read_b64_tr_b16 a[82:83], v12 offset:31232
  s_waitcnt vmcnt(17)
  ds_read_b64_tr_b16 a[224:225], v225 offset:0
  buffer_load_dwordx4 v14, s[16:19], 0 offen offset:0 lds
  ds_read_b128 v[240:243], v251 offset:48
  v_mfma_f32_32x32x16_bf16 v[144:159], v[120:123], a[88:91], v[144:159]
  ds_read_b64_tr_b16 a[84:85], v13 offset:30720
  ds_read_b64_tr_b16 a[86:87], v13 offset:31232
  ds_read_b64_tr_b16 a[226:227], v225 offset:1024
  v_mul_f32_e64 v137, v185, v137
  v_mul_f32 v138, v186, v138
  v_mul_f32 v139, v187, v139
  v_mul_f32 v140, v188, v140
  v_mul_f32 v141, v189, v141
  v_mul_f32 v142, v190, v142
  v_mul_f32 v143, v191, v143
  v_cndmask_b32 v251, v165, v167, s[90:91]
  v_mfma_f32_32x32x16_bf16 v[144:159], v[124:127], a[92:95], v[144:159]
  ds_read_b64_tr_b16 a[88:89], v12 offset:45056
  ds_read_b64_tr_b16 a[90:91], v12 offset:45568
  ds_read_b64_tr_b16 a[228:229], v226 offset:0
  buffer_load_dwordx4 v14, s[16:19], s33 offen offset:1024 lds
  v_mfma_f32_32x32x16_bf16 v[160:175], a[64:67], v[16:19], 0
  ds_read_b64_tr_b16 a[92:93], v13 offset:45056
  ds_read_b64_tr_b16 a[94:95], v13 offset:45568
  s_waitcnt lgkmcnt(10)
  ds_read_b64_tr_b16 a[230:231], v226 offset:1024
  s_waitcnt vmcnt(14)
  s_add_u32 s59, s54, 0
  s_atomic_add s5, s[20:21], s59
  v_mfma_f32_32x32x16_bf16 v[176:191], a[68:71], v[16:19], 0
  ds_read_b64_tr_b16 a[64:65], v12 offset:32768
  ds_read_b64_tr_b16 a[66:67], v12 offset:33280
  s_waitcnt lgkmcnt(2)
  buffer_load_dwordx4 v14, s[16:19], s34 offen offset:2048 lds
  v_mfma_f32_32x32x16_bf16 v[192:207], a[72:75], v[16:19], 0
  s_add_u32 m0, s80, 0
  ds_read_b64_tr_b16 a[68:69], v13 offset:32768
  ds_read_b64_tr_b16 a[70:71], v13 offset:33280
  buffer_load_dwordx4 v224, s[68:71], 0 offen offset:0 lds
  v_mfma_f32_32x32x16_bf16 v[208:223], a[76:79], v[16:19], 0
  ds_read_b64_tr_b16 a[72:73], v12 offset:47104
  ds_read_b64_tr_b16 a[74:75], v12 offset:47616
  v_mul_f32 v144, v228, v144
  v_mul_f32_e64 v145, v229, v145
  v_mul_f32 v146, v230, v146
  v_mul_f32 v147, v231, v147
  v_fma_f32 v228, v2, v128, v129
  v_mfma_f32_32x32x16_bf16 v[160:175], a[80:83], v[20:23], v[160:175]
  ds_read_b64_tr_b16 a[76:77], v13 offset:47104
  ds_read_b64_tr_b16 a[78:79], v13 offset:47616
  s_waitcnt lgkmcnt(6)
  buffer_load_dwordx4 v224, s[68:71], s39 offen offset:1024 lds
  v_add_u32 v224, 14336, v224
  v_fma_f32 v229, v2, v144, v145
  v_fma_f32 v228, -v3, v144, v228
  v_mfma_f32_32x32x16_bf16 v[176:191], a[84:87], v[20:23], v[176:191]
  ds_read_b64_tr_b16 a[80:81], v12 offset:34816
  ds_read_b64_tr_b16 a[82:83], v12 offset:35328
  s_waitcnt vmcnt(16)
  ds_read_b64_tr_b16 a[232:233], v225 offset:2048
  v_fmac_f32_e64 v229, v3, v128
  v_fma_f32 v230, v2, v228, v130
  v_fma_f32 v231, v2, v229, v146
  v_mfma_f32_32x32x16_bf16 v[192:207], a[88:91], v[20:23], v[192:207]
  s_add_u32 m0, s45, 86016
  ds_read_b64_tr_b16 a[84:85], v13 offset:34816
  ds_read_b64_tr_b16 a[86:87], v13 offset:35328
  ds_read_b64_tr_b16 a[234:235], v225 offset:3072
  buffer_load_dwordx4 v14, s[16:19], s35 offen offset:3072 lds
  v_fma_f32 v230, -v3, v229, v230
  v_fmac_f32_e64 v231, v3, v228
  v_mfma_f32_32x32x16_bf16 v[208:223], a[92:95], v[20:23], v[208:223]
  ds_read_b64_tr_b16 a[88:89], v12 offset:49152
  ds_read_b64_tr_b16 a[90:91], v12 offset:49664
  ds_read_b64_tr_b16 a[236:237], v226 offset:2048
  v_fma_f32 v228, v2, v230, v131
  v_fma_f32 v229, v2, v231, v147
  v_fma_f32 v228, -v3, v231, v228
  v_fmac_f32_e64 v229, v3, v230
  v_mfma_f32_32x32x16_bf16 v[160:175], a[64:67], v[24:27], v[160:175]
  s_add_u32 m0, s45, 90112
  ds_read_b64_tr_b16 a[92:93], v13 offset:49152
  ds_read_b64_tr_b16 a[94:95], v13 offset:49664
  s_waitcnt lgkmcnt(9)
  ds_read_b64_tr_b16 a[238:239], v226 offset:3072
  buffer_load_dwordx4 v14, s[16:19], s36 offen offset:0 lds
  v_mul_f32 v148, v232, v148
  v_mfma_f32_32x32x16_bf16 v[176:191], a[68:71], v[24:27], v[176:191]
  ds_read_b64_tr_b16 a[64:65], v12 offset:36864
  ds_read_b64_tr_b16 a[66:67], v12 offset:37376
  s_waitcnt lgkmcnt(2)
  v_fma_f32 v230, v2, v228, v132
  v_fma_f32 v231, v2, v229, v148
  v_fma_f32 v230, -v3, v229, v230
  v_fmac_f32 v231, v3, v228
  v_mfma_f32_32x32x16_bf16 v[192:207], a[72:75], v[24:27], v[192:207]
  s_add_u32 m0, s80, 2048
  ds_read_b64_tr_b16 a[68:69], v13 offset:36864
  ds_read_b64_tr_b16 a[70:71], v13 offset:37376
  buffer_load_dwordx4 v224, s[68:71], 0 offen offset:0 lds
  v_mul_f32_e64 v149, v233, v149
  v_fma_f32 v228, v2, v230, v133
  v_fma_f32 v229, v2, v231, v149
  v_mfma_f32_32x32x16_bf16 v[208:223], a[76:79], v[24:27], v[208:223]
  ds_read_b64_tr_b16 a[72:73], v12 offset:51200
  ds_read_b64_tr_b16 a[74:75], v12 offset:51712
  v_fma_f32 v228, -v3, v231, v228
  v_fmac_f32 v229, v3, v230
  v_mul_f32 v150, v234, v150
  v_fma_f32 v230, v2, v228, v134
  v_fma_f32 v231, v2, v229, v150
  v_mfma_f32_32x32x16_bf16 v[160:175], a[80:83], v[28:31], v[160:175]
  ds_read_b64_tr_b16 a[76:77], v13 offset:51200
  ds_read_b64_tr_b16 a[78:79], v13 offset:51712
  s_waitcnt lgkmcnt(6)
  buffer_load_dwordx4 v224, s[68:71], s39 offen offset:1024 lds
  v_add_u32 v224, 14336, v224
  v_fma_f32 v230, -v3, v229, v230
  v_fmac_f32 v231, v3, v228
  v_mfma_f32_32x32x16_bf16 v[176:191], a[84:87], v[28:31], v[176:191]
  s_add_u32 m0, s45, 90112
  ds_read_b64_tr_b16 a[80:81], v12 offset:38912
  ds_read_b64_tr_b16 a[82:83], v12 offset:39424
  s_waitcnt vmcnt(15)
  ds_read_b64_tr_b16 a[240:241], v225 offset:4096
  buffer_load_dwordx4 v14, s[16:19], s37 offen offset:1024 lds
  v_mul_f32 v151, v235, v151
  v_mfma_f32_32x32x16_bf16 v[192:207], a[88:91], v[28:31], v[192:207]
  ds_read_b64_tr_b16 a[84:85], v13 offset:38912
  ds_read_b64_tr_b16 a[86:87], v13 offset:39424
  ds_read_b64_tr_b16 a[242:243], v225 offset:5120
  v_fma_f32 v228, v2, v230, v135
  v_fma_f32 v229, v2, v231, v151
  v_fma_f32 v228, -v3, v231, v228
  v_fmac_f32_e64 v229, v3, v230
  v_mfma_f32_32x32x16_bf16 v[208:223], a[92:95], v[28:31], v[208:223]
  ds_read_b64_tr_b16 a[88:89], v12 offset:53248
  ds_read_b64_tr_b16 a[90:91], v12 offset:53760
  ds_read_b64_tr_b16 a[244:245], v226 offset:4096
  buffer_load_dwordx4 v14, s[16:19], s38 offen offset:2048 lds
  v_add_u32 v14, 0x62000, v14
  v_mul_f32_e64 v152, v236, v152
  v_fma_f32 v230, v2, v228, v136
  v_mfma_f32_32x32x16_bf16 v[160:175], a[64:67], v[32:35], v[160:175]
  ds_read_b64_tr_b16 a[92:93], v13 offset:53248
  ds_read_b64_tr_b16 a[94:95], v13 offset:53760
  s_waitcnt lgkmcnt(9)
  ds_read_b64_tr_b16 a[246:247], v226 offset:5120
  v_fma_f32 v231, v2, v229, v152
  v_fma_f32 v230, -v3, v229, v230
  v_fmac_f32 v231, v3, v228
  v_mfma_f32_32x32x16_bf16 v[176:191], a[68:71], v[32:35], v[176:191]
  ds_read_b64_tr_b16 a[64:65], v12 offset:40960
  ds_read_b64_tr_b16 a[66:67], v12 offset:41472
  s_waitcnt lgkmcnt(2)
  v_mul_f32 v153, v237, v153
  v_fma_f32 v228, v2, v230, v137
  v_fma_f32 v229, v2, v231, v153
  v_fma_f32 v228, -v3, v231, v228
  v_mfma_f32_32x32x16_bf16 v[192:207], a[72:75], v[32:35], v[192:207]
  s_add_u32 m0, s80, 4096
  ds_read_b64_tr_b16 a[68:69], v13 offset:40960
  ds_read_b64_tr_b16 a[70:71], v13 offset:41472
  buffer_load_dwordx4 v224, s[68:71], 0 offen offset:0 lds
  v_fmac_f32 v229, v3, v230
  v_mul_f32 v154, v238, v154
  v_fma_f32 v230, v2, v228, v138
  v_mfma_f32_32x32x16_bf16 v[208:223], a[76:79], v[32:35], v[208:223]
  ds_read_b64_tr_b16 a[72:73], v12 offset:55296
  ds_read_b64_tr_b16 a[74:75], v12 offset:55808
  v_fma_f32 v231, v2, v229, v154
  v_fma_f32 v230, -v3, v229, v230
  v_fmac_f32 v231, v3, v228
  v_mul_f32 v155, v239, v155
  v_fma_f32 v228, v2, v230, v139
  v_mfma_f32_32x32x16_bf16 v[160:175], a[80:83], v[36:39], v[160:175]
  ds_read_b64_tr_b16 a[76:77], v13 offset:55296
  ds_read_b64_tr_b16 a[78:79], v13 offset:55808
  s_waitcnt lgkmcnt(6)
  buffer_load_dwordx4 v224, s[68:71], s39 offen offset:1024 lds
  v_add_u32 v224, 14336, v224
  v_fma_f32 v229, v2, v231, v155
  v_fma_f32 v228, -v3, v231, v228
  v_mfma_f32_32x32x16_bf16 v[176:191], a[84:87], v[36:39], v[176:191]
  s_waitcnt vmcnt(17)
  s_barrier
  ds_read_b64_tr_b16 a[80:81], v252 offset:0
  ds_read_b64_tr_b16 a[82:83], v252 offset:512
  s_waitcnt vmcnt(15)
  ds_read_b64_tr_b16 a[248:249], v225 offset:6144
  v_fmac_f32_e64 v229, v3, v230
  v_mfma_f32_32x32x16_bf16 v[192:207], a[88:91], v[36:39], v[192:207]
  s_add_u32 m0, s45, 0
  ds_read_b64_tr_b16 a[84:85], v253 offset:0
  ds_read_b64_tr_b16 a[86:87], v253 offset:512
  ds_read_b64_tr_b16 a[250:251], v225 offset:7168
  buffer_load_dwordx4 v14, s[16:19], 0 offen offset:0 lds
  v_mul_f32 v156, v240, v156
  v_fma_f32 v230, v2, v228, v140
  v_mfma_f32_32x32x16_bf16 v[208:223], a[92:95], v[36:39], v[208:223]
  ds_read_b64_tr_b16 a[88:89], v252 offset:14336
  ds_read_b64_tr_b16 a[90:91], v252 offset:14848
  ds_read_b64_tr_b16 a[252:253], v226 offset:6144
  v_fma_f32 v231, v2, v229, v156
  v_fma_f32 v230, -v3, v229, v230
  v_fmac_f32 v231, v3, v228
  v_mul_f32 v157, v241, v157
  v_mfma_f32_32x32x16_bf16 v[160:175], a[64:67], v[40:43], v[160:175]
  ds_read_b64_tr_b16 a[92:93], v253 offset:14336
  ds_read_b64_tr_b16 a[94:95], v253 offset:14848
  s_waitcnt lgkmcnt(9)
  ds_read_b64_tr_b16 a[254:255], v226 offset:7168
  buffer_load_dwordx4 v14, s[16:19], s33 offen offset:1024 lds
  v_fma_f32 v228, v2, v230, v141
  v_fma_f32 v229, v2, v231, v157
  v_mfma_f32_32x32x16_bf16 v[176:191], a[68:71], v[40:43], v[176:191]
  ds_read_b64_tr_b16 a[64:65], v252 offset:2048
  ds_read_b64_tr_b16 a[66:67], v252 offset:2560
  s_waitcnt lgkmcnt(2)
  v_fma_f32 v228, -v3, v231, v228
  v_fmac_f32 v229, v3, v230
  v_mul_f32 v158, v242, v158
  v_mfma_f32_32x32x16_bf16 v[192:207], a[72:75], v[40:43], v[192:207]
  s_add_u32 m0, s80, 6144
  ds_read_b64_tr_b16 a[68:69], v253 offset:2048
  ds_read_b64_tr_b16 a[70:71], v253 offset:2560
  buffer_load_dwordx4 v224, s[68:71], 0 offen offset:0 lds
  v_fma_f32 v230, v2, v228, v142
  v_fma_f32 v231, v2, v229, v158
  v_mfma_f32_32x32x16_bf16 v[208:223], a[76:79], v[40:43], v[208:223]
  ds_read_b64_tr_b16 a[72:73], v252 offset:16384
  ds_read_b64_tr_b16 a[74:75], v252 offset:16896
  v_fma_f32 v230, -v3, v229, v230
  v_fmac_f32 v231, v3, v228
  v_mul_f32 v159, v243, v159
  v_fma_f32 v228, v2, v230, v143
  v_mfma_f32_32x32x16_bf16 v[160:175], a[80:83], v[44:47], v[160:175]
  ds_read_b64_tr_b16 a[76:77], v253 offset:16384
  ds_read_b64_tr_b16 a[78:79], v253 offset:16896
  s_waitcnt lgkmcnt(6)
  buffer_load_dwordx4 v224, s[68:71], s39 offen offset:1024 lds
  v_add_u32 v224, 14336, v224
  v_fma_f32 v229, v2, v231, v159
  v_mfma_f32_32x32x16_bf16 v[176:191], a[84:87], v[44:47], v[176:191]
  s_add_u32 m0, s45, 0
  ds_read_b64_tr_b16 a[80:81], v252 offset:4096
  ds_read_b64_tr_b16 a[82:83], v252 offset:4608
  s_waitcnt vmcnt(17)
  ds_read_b64_tr_b16 a[0:1], v225 offset:8192
  buffer_load_dwordx4 v14, s[16:19], s34 offen offset:2048 lds
  v_mfma_f32_32x32x16_bf16 v[192:207], a[88:91], v[44:47], v[192:207]
  ds_read_b64_tr_b16 a[84:85], v253 offset:4096
  ds_read_b64_tr_b16 a[86:87], v253 offset:4608
  ds_read_b64_tr_b16 a[2:3], v225 offset:9216
  v_fma_f32 v228, -v3, v231, v228
  v_fmac_f32 v229, v3, v230
  ds_write_b64 v254, v[228:229] offset:2048
  v_mfma_f32_32x32x16_bf16 v[208:223], a[92:95], v[44:47], v[208:223]
  ds_read_b64_tr_b16 a[88:89], v252 offset:18432
  ds_read_b64_tr_b16 a[90:91], v252 offset:18944
  ds_read_b64_tr_b16 a[4:5], v226 offset:8192
  buffer_load_dwordx4 v14, s[16:19], s35 offen offset:3072 lds
  v_mfma_f32_32x32x16_bf16 v[160:175], a[64:67], v[48:51], v[160:175]
  ds_read_b64_tr_b16 a[92:93], v253 offset:18432
  ds_read_b64_tr_b16 a[94:95], v253 offset:18944
  s_waitcnt lgkmcnt(10)
  ds_read_b64_tr_b16 a[6:7], v226 offset:9216
  v_mfma_f32_32x32x16_bf16 v[176:191], a[68:71], v[48:51], v[176:191]
  s_add_u32 m0, s45, 4096
  ds_read_b64_tr_b16 a[64:65], v252 offset:6144
  ds_read_b64_tr_b16 a[66:67], v252 offset:6656
  s_waitcnt lgkmcnt(2)
  buffer_load_dwordx4 v14, s[16:19], s36 offen offset:0 lds
  v_mfma_f32_32x32x16_bf16 v[192:207], a[72:75], v[48:51], v[192:207]
  s_add_u32 m0, s80, 8192
  ds_read_b64_tr_b16 a[68:69], v253 offset:6144
  ds_read_b64_tr_b16 a[70:71], v253 offset:6656
  buffer_load_dwordx4 v224, s[68:71], 0 offen offset:0 lds
  s_barrier
  ds_read_b64 v[28:29], v254 offset:256
  ds_read_b64 v[26:27], v254 offset:512
  v_mfma_f32_32x32x16_bf16 v[208:223], a[76:79], v[48:51], v[208:223]
  ds_read_b64_tr_b16 a[72:73], v252 offset:20480
  ds_read_b64_tr_b16 a[74:75], v252 offset:20992
  ds_read_b64 v[24:25], v254 offset:768
  ds_read_b64 v[22:23], v254 offset:1024
  ds_read_b64 v[20:21], v254 offset:1280
  v_mfma_f32_32x32x16_bf16 v[160:175], a[80:83], v[52:55], v[160:175]
  ds_read_b64_tr_b16 a[76:77], v253 offset:20480
  ds_read_b64_tr_b16 a[78:79], v253 offset:20992
  s_waitcnt lgkmcnt(11)
  buffer_load_dwordx4 v224, s[68:71], s39 offen offset:1024 lds
  v_add_u32 v224, 14336, v224
  ds_read_b64 v[18:19], v254 offset:1536
  ds_read_b64 v[16:17], v254 offset:1792
  v_mfma_f32_32x32x16_bf16 v[176:191], a[84:87], v[52:55], v[176:191]
  ds_read_b64_tr_b16 a[80:81], v252 offset:8192
  ds_read_b64_tr_b16 a[82:83], v252 offset:8704
  s_waitcnt vmcnt(17)
  ds_read_b64_tr_b16 a[8:9], v225 offset:0
  v_mfma_f32_32x32x16_bf16 v[192:207], a[88:91], v[52:55], v[192:207]
  s_add_u32 m0, s45, 4096
  ds_read_b64_tr_b16 a[84:85], v253 offset:8192
  ds_read_b64_tr_b16 a[86:87], v253 offset:8704
  ds_read_b64_tr_b16 a[10:11], v225 offset:1024
  buffer_load_dwordx4 v14, s[16:19], s37 offen offset:1024 lds
  s_waitcnt lgkmcnt(6)
  v_fmac_f32 v26, v4, v28
  v_fmac_f32 v27, v4, v29
  v_mfma_f32_32x32x16_bf16 v[208:223], a[92:95], v[52:55], v[208:223]
  ds_read_b64_tr_b16 a[88:89], v252 offset:22528
  ds_read_b64_tr_b16 a[90:91], v252 offset:23040
  ds_read_b64_tr_b16 a[12:13], v226 offset:0
  v_fma_f32 v26, -v5, v29, v26
  v_fmac_f32_e64 v27, v5, v28
  v_fmac_f32 v24, v4, v26
  v_fmac_f32 v25, v4, v27
  v_fma_f32 v24, -v5, v27, v24
  v_mfma_f32_32x32x16_bf16 v[160:175], a[64:67], v[56:59], v[160:175]
  ds_read_b64_tr_b16 a[92:93], v253 offset:22528
  ds_read_b64_tr_b16 a[94:95], v253 offset:23040
  s_waitcnt lgkmcnt(9)
  ds_read_b64_tr_b16 a[14:15], v226 offset:1024
  buffer_load_dwordx4 v14, s[16:19], s38 offen offset:2048 lds
  v_fmac_f32 v25, v5, v26
  v_fmac_f32 v22, v4, v24
  v_fmac_f32 v23, v4, v25
  v_mfma_f32_32x32x16_bf16 v[176:191], a[68:71], v[56:59], v[176:191]
  ds_read_b64_tr_b16 a[64:65], v252 offset:10240
  ds_read_b64_tr_b16 a[66:67], v252 offset:10752
  s_waitcnt lgkmcnt(2)
  v_fma_f32 v22, -v5, v25, v22
  v_fmac_f32 v23, v5, v24
  v_fmac_f32 v20, v4, v22
  v_fmac_f32 v21, v4, v23
  v_fma_f32 v20, -v5, v23, v20
  v_mfma_f32_32x32x16_bf16 v[192:207], a[72:75], v[56:59], v[192:207]
  s_add_u32 m0, s80, 0
  ds_read_b64_tr_b16 a[68:69], v253 offset:10240
  ds_read_b64_tr_b16 a[70:71], v253 offset:10752
  buffer_load_dwordx4 v224, s[68:71], 0 offen offset:0 lds
  s_add_u32 s4, s85, 0
  s_add_u32 s30, s85, 128
  s_load_dword s100, s[20:21], s4 glc
  s_load_dword s101, s[20:21], s30 glc
  v_mfma_f32_32x32x16_bf16 v[208:223], a[76:79], v[56:59], v[208:223]
  ds_read_b64_tr_b16 a[72:73], v252 offset:24576
  ds_read_b64_tr_b16 a[74:75], v252 offset:25088
  v_fmac_f32_e64 v21, v5, v22
  v_fmac_f32 v18, v4, v20
  v_fmac_f32 v19, v4, v21
  v_fma_f32 v18, -v5, v21, v18
  v_fmac_f32 v19, v5, v20
  v_fmac_f32 v16, v4, v18
  v_mfma_f32_32x32x16_bf16 v[160:175], a[80:83], v[60:63], v[160:175]
  ds_read_b64_tr_b16 a[76:77], v253 offset:24576
  ds_read_b64_tr_b16 a[78:79], v253 offset:25088
  s_waitcnt lgkmcnt(6)
  buffer_load_dwordx4 v224, s[68:71], s39 offen offset:1024 lds
  v_add_u32 v224, 14336, v224
  v_fmac_f32 v17, v4, v19
  v_fma_f32 v16, -v5, v19, v16
  v_fmac_f32_e64 v17, v5, v18
  v_mfma_f32_32x32x16_bf16 v[176:191], a[84:87], v[60:63], v[176:191]
  ds_read_b64_tr_b16 a[80:81], v252 offset:12288
  ds_read_b64_tr_b16 a[82:83], v252 offset:12800
  s_waitcnt vmcnt(17)
  ds_read_b64_tr_b16 a[16:17], v225 offset:2048
  v_fmac_f32 v228, v4, v16
  v_fmac_f32_e64 v229, v4, v17
  v_fma_f32 v228, -v5, v17, v228
  v_fmac_f32_e64 v229, v5, v16
  v_mfma_f32_32x32x16_bf16 v[192:207], a[88:91], v[60:63], v[192:207]
  ds_read_b64_tr_b16 a[84:85], v253 offset:12288
  ds_read_b64_tr_b16 a[86:87], v253 offset:12800
  ds_read_b64_tr_b16 a[18:19], v225 offset:3072
  v_mov_b32_e64 v230, v227
  v_lshlrev_b32 v232, 1, v255
  s_cmp_eq_u32 s3, 3
  s_cbranch_scc0 L_np
  s_mov_b32 exec_lo, 0
  buffer_store_dwordx3 v[228:230], v232, s[76:79], s49 offen sc1
  s_mov_b64 exec, -1
L_np:
  v_mfma_f32_32x32x16_bf16 v[208:223], a[92:95], v[60:63], v[208:223]
  ds_read_b64_tr_b16 a[88:89], v252 offset:26624
  ds_read_b64_tr_b16 a[90:91], v252 offset:27136
  ds_read_b64_tr_b16 a[20:21], v226 offset:2048
  v_mul_f32 v4, v10, v16
  v_mul_f32_e64 v5, v11, v16
  v_fma_f32 v4, -v11, v17, v4
  v_mfma_f32_32x32x16_bf16 v[160:175], a[64:67], v[64:67], v[160:175]
  ds_read_b64_tr_b16 a[92:93], v253 offset:26624
  ds_read_b64_tr_b16 a[94:95], v253 offset:27136
  s_waitcnt lgkmcnt(9)
  ds_read_b64_tr_b16 a[22:23], v226 offset:3072
  v_fma_f32 v5, -v10, v17, -v5
  s_lshr_b32 s43, s3, 1
  v_mfma_f32_32x32x16_bf16 v[176:191], a[68:71], v[64:67], v[176:191]
  s_waitcnt vmcnt(15)
  s_barrier
  ds_read_b64_tr_b16 a[64:65], v252 offset:28672
  ds_read_b64_tr_b16 a[66:67], v252 offset:29184
  s_waitcnt lgkmcnt(2)
  s_mul_i32 s43, s43, 172032
  v_mfma_f32_32x32x16_bf16 v[192:207], a[72:75], v[64:67], v[192:207]
  s_add_u32 m0, s80, 2048
  ds_read_b64_tr_b16 a[68:69], v253 offset:28672
  ds_read_b64_tr_b16 a[70:71], v253 offset:29184
  buffer_load_dwordx4 v224, s[68:71], 0 offen offset:0 lds
  v_add_u32 v242, s43, v1
  s_xor_b32 s43, s43, 172032
  v_mfma_f32_32x32x16_bf16 v[208:223], a[76:79], v[64:67], v[208:223]
  ds_read_b64_tr_b16 a[72:73], v252 offset:43008
  ds_read_b64_tr_b16 a[74:75], v252 offset:43520
  v_add_u32 v243, s43, v1
  v_lshrrev_b32 v34, 5, v0
  s_mov_b32 s55, 14336
  v_mul_u32_u24_e64 v240, s55, v34
  v_mfma_f32_32x32x16_bf16 v[160:175], a[80:83], v[68:71], v[160:175]
  ds_read_b64_tr_b16 a[76:77], v253 offset:43008
  ds_read_b64_tr_b16 a[78:79], v253 offset:43520
  s_waitcnt lgkmcnt(6)
  buffer_load_dwordx4 v224, s[68:71], s39 offen offset:1024 lds
  v_add_u32 v224, 14336, v224
  v_lshl_add_u32 v240, v255, 1, v240
  v_mfma_f32_32x32x16_bf16 v[176:191], a[84:87], v[68:71], v[176:191]
  s_add_u32 m0, s42, 28672
  ds_read_b64_tr_b16 a[80:81], v252 offset:30720
  ds_read_b64_tr_b16 a[82:83], v252 offset:31232
  s_waitcnt vmcnt(15)
  ds_read_b64_tr_b16 a[24:25], v225 offset:4096
  buffer_load_dwordx4 v244, s[64:67], s87 offen offset:0 lds
  v_mfma_f32_32x32x16_bf16 v[192:207], a[88:91], v[68:71], v[192:207]
  ds_read_b64_tr_b16 a[84:85], v253 offset:30720
  ds_read_b64_tr_b16 a[86:87], v253 offset:31232
  ds_read_b64_tr_b16 a[26:27], v225 offset:5120
  s_mul_i32 s55, s3, 28672
  s_add_u32 s55, s55, s49
  s_sub_u32 s55, s55, 114688
  v_mfma_f32_32x32x16_bf16 v[208:223], a[92:95], v[68:71], v[208:223]
  s_add_u32 m0, s42, 32640
  ds_read_b64_tr_b16 a[88:89], v252 offset:45056
  ds_read_b64_tr_b16 a[90:91], v252 offset:45568
  ds_read_b64_tr_b16 a[28:29], v226 offset:4096
  buffer_load_dwordx4 v244, s[64:67], s87 offen offset:128 lds
  v_add_u32 v240, s55, v240
  v_mfma_f32_32x32x16_bf16 v[160:175], a[64:67], v[72:75], v[160:175]
  ds_read_b64_tr_b16 a[92:93], v253 offset:45056
  ds_read_b64_tr_b16 a[94:95], v253 offset:45568
  s_waitcnt lgkmcnt(9)
  ds_read_b64_tr_b16 a[30:31], v226 offset:5120
  v_add_u32 v241, 7168, v240
  v_lshlrev_b32 v32, 5, v34
  v_mfma_f32_32x32x16_bf16 v[176:191], a[68:71], v[72:75], v[176:191]
  s_add_u32 m0, s42, 36608
  ds_read_b64_tr_b16 a[64:65], v252 offset:32768
  ds_read_b64_tr_b16 a[66:67], v252 offset:33280
  buffer_load_dwordx4 v244, s[64:67], s87 offen offset:256 lds
  v_mad_u32_u24 v32, v255, 10, v32
  v_add_u32_e64 v32, s80, v32
  v_mfma_f32_32x32x16_bf16 v[192:207], a[72:75], v[72:75], v[192:207]
  ds_read_b64_tr_b16 a[68:69], v253 offset:32768
  ds_read_b64_tr_b16 a[70:71], v253 offset:33280
  v_bfe_u32 v235, v0, 2, 2
  v_lshl_add_u32 v33, v34, 3, v235
  v_mul_u32_u24 v33, 80, v33
  v_and_b32_e64 v235, 1, v0
  v_mfma_f32_32x32x16_bf16 v[208:223], a[76:79], v[72:75], v[208:223]
  s_add_u32 m0, s42, 40576
  ds_read_b64_tr_b16 a[72:73], v252 offset:47104
  ds_read_b64_tr_b16 a[74:75], v252 offset:47616
  buffer_load_dwordx4 v244, s[64:67], s87 offen offset:384 lds
  v_lshl_add_u32 v33, v235, 5, v33
  v_and_b32_e64 v235, 16, v0
  v_mfma_f32_32x32x16_bf16 v[160:175], a[80:83], v[76:79], v[160:175]
  ds_read_b64_tr_b16 a[76:77], v253 offset:47104
  ds_read_b64_tr_b16 a[78:79], v253 offset:47616
  s_waitcnt lgkmcnt(6)
  v_add_u32 v33, v235, v33
  v_and_b32_e64 v235, 2, v0
  v_lshl_add_u32 v33, v235, 2, v33
  v_mfma_f32_32x32x16_bf16 v[176:191], a[84:87], v[76:79], v[176:191]
  s_add_u32 m0, s42, 44544
  ds_read_b64_tr_b16 a[80:81], v252 offset:34816
  ds_read_b64_tr_b16 a[82:83], v252 offset:35328
  s_waitcnt vmcnt(15)
  ds_read_b64_tr_b16 a[32:33], v225 offset:6144
  buffer_load_dwordx4 v244, s[64:67], s87 offen offset:512 lds
  v_mfma_f32_32x32x16_bf16 v[192:207], a[88:91], v[76:79], v[192:207]
  ds_read_b64_tr_b16 a[84:85], v253 offset:34816
  ds_read_b64_tr_b16 a[86:87], v253 offset:35328
  ds_read_b64_tr_b16 a[34:35], v225 offset:7168
  v_add_u32 v33, s80, v33
  v_lshl_add_u32 v35, v34, 9, v255
  s_lshl_b32 s43, s3, 10
  v_mfma_f32_32x32x16_bf16 v[208:223], a[92:95], v[76:79], v[208:223]
  s_add_u32 m0, s42, 48512
  ds_read_b64_tr_b16 a[88:89], v252 offset:49152
  ds_read_b64_tr_b16 a[90:91], v252 offset:49664
  ds_read_b64_tr_b16 a[36:37], v226 offset:6144
  buffer_load_dwordx4 v244, s[64:67], s87 offen offset:640 lds
  s_add_u32 s43, s43, 155648
  v_mfma_f32_32x32x16_bf16 v[160:175], a[64:67], v[80:83], v[160:175]
  ds_read_b64_tr_b16 a[92:93], v253 offset:49152
  ds_read_b64_tr_b16 a[94:95], v253 offset:49664
  s_waitcnt lgkmcnt(9)
  ds_read_b64_tr_b16 a[38:39], v226 offset:7168
  v_add_u32_e64 v35, s43, v35
  v_lshl_add_u32 v34, v34, 11, v255
  v_mfma_f32_32x32x16_bf16 v[176:191], a[68:71], v[80:83], v[176:191]
  s_add_u32 m0, s42, 52480
  ds_read_b64_tr_b16 a[64:65], v252 offset:36864
  ds_read_b64_tr_b16 a[66:67], v252 offset:37376
  buffer_load_dwordx4 v244, s[64:67], s87 offen offset:768 lds
  v_add_u32 v34, 155648, v34
  v_mul_f32_e64 v230, v11, v128
  v_mfma_f32_32x32x16_bf16 v[192:207], a[72:75], v[80:83], v[192:207]
  ds_read_b64_tr_b16 a[68:69], v253 offset:36864
  ds_read_b64_tr_b16 a[70:71], v253 offset:37376
  s_waitcnt lgkmcnt(0)
  s_add_u32 s100, s100, s101
  s_cmp_eq_u32 s100, 28
  s_cbranch_scc0 L_f0_spin
L_f0_ok:
  v_mfma_f32_32x32x16_bf16 v[208:223], a[76:79], v[80:83], v[208:223]
  ds_read_b64_tr_b16 a[72:73], v252 offset:51200
  ds_read_b64_tr_b16 a[74:75], v252 offset:51712
  v_mul_f32_e64 v128, v10, v128
  v_fma_f32 v128, -v11, v144, v128
  v_fma_f32 v144, -v10, v144, -v230
  v_mul_f32_e64 v231, v11, v129
  v_mfma_f32_32x32x16_bf16 v[160:175], a[80:83], v[84:87], v[160:175]
  s_add_u32 s84, s83, 0
  ds_read_b64_tr_b16 a[76:77], v253 offset:51200
  ds_read_b64_tr_b16 a[78:79], v253 offset:51712
  buffer_load_dwordx4 v[48:51], v242, s[20:23], s84 offen offset:0 sc1
  v_mul_f32 v129, v10, v129
  v_fma_f32 v129, -v11, v145, v129
  v_mfma_f32_32x32x16_bf16 v[176:191], a[84:87], v[84:87], v[176:191]
  ds_read_b64_tr_b16 a[80:81], v252 offset:38912
  ds_read_b64_tr_b16 a[82:83], v252 offset:39424
  s_waitcnt vmcnt(14)
  ds_read_b64_tr_b16 a[40:41], v225 offset:8192
  v_fma_f32 v145, -v10, v145, -v231
  v_mul_f32 v230, v11, v130
  v_mfma_f32_32x32x16_bf16 v[192:207], a[88:91], v[84:87], v[192:207]
  ds_read_b64_tr_b16 a[84:85], v253 offset:38912
  ds_read_b64_tr_b16 a[86:87], v253 offset:39424
  ds_read_b64_tr_b16 a[42:43], v225 offset:9216
  buffer_load_dwordx4 v[52:55], v243, s[20:23], s84 offen offset:0 sc1
  v_mul_f32_e64 v130, v10, v130
  v_fma_f32 v130, -v11, v146, v130
  v_mfma_f32_32x32x16_bf16 v[208:223], a[92:95], v[84:87], v[208:223]
  ds_read_b64_tr_b16 a[88:89], v252 offset:53248
  ds_read_b64_tr_b16 a[90:91], v252 offset:53760
  ds_read_b64_tr_b16 a[44:45], v226 offset:8192
  v_fma_f32 v146, -v10, v146, -v230
  v_mul_f32 v231, v11, v131
  v_mul_f32 v131, v10, v131
  v_mfma_f32_32x32x16_bf16 v[160:175], a[64:67], v[88:91], v[160:175]
  ds_read_b64_tr_b16 a[92:93], v253 offset:53248
  ds_read_b64_tr_b16 a[94:95], v253 offset:53760
  s_waitcnt lgkmcnt(9)
  ds_read_b64_tr_b16 a[46:47], v226 offset:9216
  buffer_load_dwordx4 v[56:59], v242, s[20:23], s84 offen offset:1024 sc1
  v_fma_f32 v131, -v11, v147, v131
  v_mfma_f32_32x32x16_bf16 v[176:191], a[68:71], v[88:91], v[176:191]
  ds_read_b64_tr_b16 a[64:65], v252 offset:40960
  ds_read_b64_tr_b16 a[66:67], v252 offset:41472
  v_fma_f32 v147, -v10, v147, -v231
  v_mul_f32 v230, v11, v132
  v_mul_f32_e64 v132, v10, v132
  v_fma_f32 v132, -v11, v148, v132
  v_mfma_f32_32x32x16_bf16 v[192:207], a[72:75], v[88:91], v[192:207]
  ds_read_b64_tr_b16 a[68:69], v253 offset:40960
  ds_read_b64_tr_b16 a[70:71], v253 offset:41472
  buffer_load_dwordx4 v[60:63], v243, s[20:23], s84 offen offset:1024 sc1
  v_fma_f32 v148, -v10, v148, -v230
  v_mul_f32 v231, v11, v133
  v_mul_f32 v133, v10, v133
  v_mfma_f32_32x32x16_bf16 v[208:223], a[76:79], v[88:91], v[208:223]
  ds_read_b64_tr_b16 a[72:73], v252 offset:55296
  ds_read_b64_tr_b16 a[74:75], v252 offset:55808
  v_fma_f32 v133, -v11, v149, v133
  v_fma_f32 v149, -v10, v149, -v231
  v_mul_f32 v230, v11, v134
  v_mul_f32 v134, v10, v134
  v_mfma_f32_32x32x16_bf16 v[160:175], a[80:83], v[92:95], v[160:175]
  ds_read_b64_tr_b16 a[76:77], v253 offset:55296
  ds_read_b64_tr_b16 a[78:79], v253 offset:55808
  s_waitcnt lgkmcnt(6)
  buffer_load_dwordx4 v[64:67], v242, s[20:23], s84 offen offset:2048 sc1
  v_fma_f32 v134, -v11, v150, v134
  v_fma_f32 v150, -v10, v150, -v230
  v_mfma_f32_32x32x16_bf16 v[176:191], a[84:87], v[92:95], v[176:191]
  s_waitcnt vmcnt(16)
  s_barrier
  ds_read_b64_tr_b16 a[80:81], v12 offset:0
  ds_read_b64_tr_b16 a[82:83], v12 offset:512
  s_waitcnt vmcnt(14)
  ds_read_b64_tr_b16 a[48:49], v225 offset:0
  v_mfma_f32_32x32x16_bf16 v[192:207], a[88:91], v[92:95], v[192:207]
  ds_read_b64_tr_b16 a[84:85], v12 offset:14336
  ds_read_b64_tr_b16 a[86:87], v12 offset:14848
  ds_read_b64_tr_b16 a[50:51], v225 offset:1024
  buffer_load_dwordx4 v[68:71], v243, s[20:23], s84 offen offset:2048 sc1
  v_mul_f32 v231, v11, v135
  v_mul_f32 v135, v10, v135
  v_mfma_f32_32x32x16_bf16 v[208:223], a[92:95], v[92:95], v[208:223]
  ds_read_b64_tr_b16 a[88:89], v12 offset:2048
  ds_read_b64_tr_b16 a[90:91], v12 offset:2560
  ds_read_b64_tr_b16 a[52:53], v226 offset:0
  v_fma_f32 v135, -v11, v151, v135
  v_fma_f32 v151, -v10, v151, -v231
  v_mfma_f32_32x32x16_bf16 v[160:175], a[64:67], v[96:99], v[160:175]
  s_add_u32 m0, s42, 57344
  ds_read_b64_tr_b16 a[92:93], v12 offset:16384
  ds_read_b64_tr_b16 a[94:95], v12 offset:16896
  s_waitcnt lgkmcnt(9)
  ds_read_b64_tr_b16 a[54:55], v226 offset:1024
  buffer_load_dwordx4 v244, s[96:99], s87 offen offset:0 lds
  v_mfma_f32_32x32x16_bf16 v[176:191], a[68:71], v[96:99], v[176:191]
  ds_read_b64_tr_b16 a[64:65], v12 offset:4096
  ds_read_b64_tr_b16 a[66:67], v12 offset:4608
  v_mul_f32 v230, v11, v136
  v_mul_f32_e64 v136, v10, v136
  v_fma_f32 v136, -v11, v152, v136
  v_mfma_f32_32x32x16_bf16 v[192:207], a[72:75], v[96:99], v[192:207]
  s_add_u32 m0, s42, 61312
  ds_read_b64_tr_b16 a[68:69], v12 offset:18432
  ds_read_b64_tr_b16 a[70:71], v12 offset:18944
  buffer_load_dwordx4 v244, s[96:99], s87 offen offset:128 lds
  v_fma_f32 v152, -v10, v152, -v230
  v_mfma_f32_32x32x16_bf16 v[208:223], a[76:79], v[96:99], v[208:223]
  ds_read_b64_tr_b16 a[72:73], v12 offset:6144
  ds_read_b64_tr_b16 a[74:75], v12 offset:6656
  v_mul_f32 v231, v11, v137
  v_mul_f32 v137, v10, v137
  v_fma_f32 v137, -v11, v153, v137
  v_mfma_f32_32x32x16_bf16 v[160:175], a[80:83], v[100:103], v[160:175]
  s_add_u32 m0, s42, 65280
  ds_read_b64_tr_b16 a[76:77], v12 offset:20480
  ds_read_b64_tr_b16 a[78:79], v12 offset:20992
  s_waitcnt lgkmcnt(6)
  buffer_load_dwordx4 v244, s[96:99], s87 offen offset:256 lds
  v_mfma_f32_32x32x16_bf16 v[192:207], a[84:87], v[100:103], v[192:207]
  ds_read_b64_tr_b16 a[80:81], v12 offset:8192
  ds_read_b64_tr_b16 a[82:83], v12 offset:8704
  s_waitcnt vmcnt(16)
  ds_read_b64_tr_b16 a[56:57], v225 offset:2048
  v_fma_f32 v153, -v10, v153, -v231
  v_mfma_f32_32x32x16_bf16 v[160:175], a[88:91], v[104:107], v[160:175]
  s_add_u32 m0, s42, 69248
  ds_read_b64_tr_b16 a[84:85], v12 offset:22528
  ds_read_b64_tr_b16 a[86:87], v12 offset:23040
  ds_read_b64_tr_b16 a[58:59], v225 offset:3072
  buffer_load_dwordx3 v[232:234], v240, s[76:79], 0 offen sc1
  buffer_load_dwordx4 v244, s[96:99], s87 offen offset:384 lds
  v_mfma_f32_32x32x16_bf16 v[192:207], a[92:95], v[104:107], v[192:207]
  ds_read_b64_tr_b16 a[88:89], v12 offset:10240
  ds_read_b64_tr_b16 a[90:91], v12 offset:10752
  ds_read_b64_tr_b16 a[60:61], v226 offset:2048
  buffer_load_dwordx3 v[236:238], v241, s[76:79], 0 offen sc1
  v_mul_f32_e64 v230, v11, v138
  v_mfma_f32_32x32x16_bf16 v[160:175], a[64:67], v[108:111], v[160:175]
  s_add_u32 m0, s42, 73216
  ds_read_b64_tr_b16 a[92:93], v12 offset:24576
  ds_read_b64_tr_b16 a[94:95], v12 offset:25088
  s_waitcnt lgkmcnt(9)
  ds_read_b64_tr_b16 a[62:63], v226 offset:3072
  buffer_load_dwordx4 v244, s[96:99], s87 offen offset:512 lds
  v_mfma_f32_32x32x16_bf16 v[192:207], a[68:71], v[108:111], v[192:207]
  ds_read_b64_tr_b16 a[64:65], v12 offset:12288
  ds_read_b64_tr_b16 a[66:67], v12 offset:12800
  v_mul_f32 v138, v10, v138
  v_fma_f32 v138, -v11, v154, v138
  v_fma_f32 v154, -v10, v154, -v230
  v_mfma_f32_32x32x16_bf16 v[160:175], a[72:75], v[112:115], v[160:175]
  s_add_u32 m0, s42, 77184
  ds_read_b64_tr_b16 a[68:69], v12 offset:26624
  ds_read_b64_tr_b16 a[70:71], v12 offset:27136
  buffer_load_dwordx4 v244, s[96:99], s87 offen offset:640 lds
  v_mul_f32_e64 v231, v11, v139
  v_mfma_f32_32x32x16_bf16 v[192:207], a[76:79], v[112:115], v[192:207]
  ds_read_b64_tr_b16 a[72:73], v13 offset:0
  ds_read_b64_tr_b16 a[74:75], v13 offset:512
  v_mul_f32_e64 v139, v10, v139
  v_fma_f32 v139, -v11, v155, v139
  v_fma_f32 v155, -v10, v155, -v231
  v_mfma_f32_32x32x16_bf16 v[160:175], a[80:83], v[116:119], v[160:175]
  s_add_u32 m0, s42, 81152
  ds_read_b64_tr_b16 a[76:77], v13 offset:14336
  ds_read_b64_tr_b16 a[78:79], v13 offset:14848
  s_waitcnt lgkmcnt(6)
  buffer_load_dwordx4 v244, s[96:99], s87 offen offset:768 lds
  v_mfma_f32_32x32x16_bf16 v[192:207], a[84:87], v[116:119], v[192:207]
  ds_read_b64_tr_b16 a[80:81], v13 offset:2048
  ds_read_b64_tr_b16 a[82:83], v13 offset:2560
  v_mul_f32 v230, v11, v140
  v_mul_f32_e64 v140, v10, v140
  v_fma_f32 v140, -v11, v156, v140
  v_mfma_f32_32x32x16_bf16 v[160:175], a[88:91], v[120:123], v[160:175]
  ds_read_b64_tr_b16 a[84:85], v13 offset:16384
  ds_read_b64_tr_b16 a[86:87], v13 offset:16896
  buffer_load_dwordx4 v[72:75], v242, s[20:23], s84 offen offset:3072 sc1
  v_fma_f32 v156, -v10, v156, -v230
  v_mul_f32_e64 v231, v11, v141
  v_mfma_f32_32x32x16_bf16 v[192:207], a[92:95], v[120:123], v[192:207]
  ds_read_b64_tr_b16 a[88:89], v13 offset:4096
  ds_read_b64_tr_b16 a[90:91], v13 offset:4608
  v_mul_f32_e64 v141, v10, v141
  v_fma_f32 v141, -v11, v157, v141
  v_fma_f32 v157, -v10, v157, -v231
  v_mfma_f32_32x32x16_bf16 v[160:175], a[64:67], v[124:127], v[160:175]
  ds_read_b64_tr_b16 a[92:93], v13 offset:18432
  ds_read_b64_tr_b16 a[94:95], v13 offset:18944
  s_waitcnt lgkmcnt(6)
  buffer_load_dwordx4 v[76:79], v243, s[20:23], s84 offen offset:3072 sc1
  v_mul_f32 v230, v11, v142
  v_mfma_f32_32x32x16_bf16 v[192:207], a[68:71], v[124:127], v[192:207]
  ds_read_b64_tr_b16 a[64:65], v13 offset:6144
  ds_read_b64_tr_b16 a[66:67], v13 offset:6656
  v_mul_f32_e64 v142, v10, v142
  v_fma_f32 v142, -v11, v158, v142
  v_fma_f32 v158, -v10, v158, -v230
  v_mfma_f32_32x32x16_bf16 v[176:191], a[72:75], v[100:103], v[176:191]
  s_add_u32 s84, s83, 4096
  ds_read_b64_tr_b16 a[68:69], v13 offset:20480
  ds_read_b64_tr_b16 a[70:71], v13 offset:20992
  buffer_load_dwordx4 v[80:83], v242, s[20:23], s84 offen offset:0 sc1
  v_mul_f32_e64 v231, v11, v143
  v_mfma_f32_32x32x16_bf16 v[208:223], a[76:79], v[100:103], v[208:223]
  ds_read_b64_tr_b16 a[72:73], v13 offset:8192
  ds_read_b64_tr_b16 a[74:75], v13 offset:8704
  v_mul_f32_e64 v143, v10, v143
  v_fma_f32 v143, -v11, v159, v143
  v_fma_f32 v159, -v10, v159, -v231
  v_mfma_f32_32x32x16_bf16 v[176:191], a[80:83], v[104:107], v[176:191]
  ds_read_b64_tr_b16 a[76:77], v13 offset:22528
  ds_read_b64_tr_b16 a[78:79], v13 offset:23040
  s_waitcnt lgkmcnt(6)
  buffer_load_dwordx4 v[84:87], v243, s[20:23], s84 offen offset:0 sc1
  v_mul_f32 v160, v160, v192
  v_mfma_f32_32x32x16_bf16 v[208:223], a[84:87], v[104:107], v[208:223]
  ds_read_b64_tr_b16 a[80:81], v13 offset:10240
  ds_read_b64_tr_b16 a[82:83], v13 offset:10752
  v_mul_f32_e64 v161, v161, v193
  v_cvt_pk_bf16_f32 v192, v160, v161
  v_mul_f32_e64 v162, v162, v194
  v_mfma_f32_32x32x16_bf16 v[176:191], a[88:91], v[108:111], v[176:191]
  ds_read_b64_tr_b16 a[84:85], v13 offset:24576
  ds_read_b64_tr_b16 a[86:87], v13 offset:25088
  buffer_load_dwordx4 v[88:91], v242, s[20:23], s84 offen offset:1024 sc1
  v_mul_f32_e64 v163, v163, v195
  v_cvt_pk_bf16_f32 v193, v162, v163
  v_mfma_f32_32x32x16_bf16 v[208:223], a[92:95], v[108:111], v[208:223]
  ds_read_b64_tr_b16 a[88:89], v13 offset:12288
  ds_read_b64_tr_b16 a[90:91], v13 offset:12800
  v_mul_f32 v164, v164, v196
  v_mul_f32 v165, v165, v197
  v_cvt_pk_bf16_f32 v194, v164, v165
  v_mfma_f32_32x32x16_bf16 v[176:191], a[64:67], v[112:115], v[176:191]
  ds_read_b64_tr_b16 a[92:93], v13 offset:26624
  ds_read_b64_tr_b16 a[94:95], v13 offset:27136
  s_waitcnt lgkmcnt(6)
  buffer_load_dwordx4 v[92:95], v243, s[20:23], s84 offen offset:1024 sc1
  v_mul_f32 v166, v166, v198
  v_mfma_f32_32x32x16_bf16 v[208:223], a[68:71], v[112:115], v[208:223]
  v_mul_f32_e64 v167, v167, v199
  v_cvt_pk_bf16_f32 v195, v166, v167
  buffer_store_dwordx4 v[192:195], v1, s[20:23], s52 offen offset:0 sc1
  v_mul_f32 v168, v168, v200
  v_mul_f32 v169, v169, v201
  v_mfma_f32_32x32x16_bf16 v[176:191], a[72:75], v[116:119], v[176:191]
  v_cvt_pk_bf16_f32 v196, v168, v169
  v_mul_f32 v170, v170, v202
  v_mul_f32 v171, v171, v203
  v_cvt_pk_bf16_f32 v197, v170, v171
  v_mul_f32_e64 v172, v172, v204
  v_mfma_f32_32x32x16_bf16 v[208:223], a[76:79], v[116:119], v[208:223]
  v_mul_f32_e64 v173, v173, v205
  v_cvt_pk_bf16_f32 v198, v172, v173
  v_mul_f32 v174, v174, v206
  v_mul_f32 v175, v175, v207
  v_cvt_pk_bf16_f32 v199, v174, v175
  v_mfma_f32_32x32x16_bf16 v[176:191], a[80:83], v[120:123], v[176:191]
  s_waitcnt lgkmcnt(0)
  buffer_store_dwordx4 v[196:199], v1, s[20:23], s52 offen offset:1024 sc1
  v_mfma_f32_32x32x16_bf16 v[208:223], a[84:87], v[120:123], v[208:223]
  v_mfma_f32_32x32x16_bf16 v[176:191], a[88:91], v[124:127], v[176:191]
  v_mfma_f32_32x32x16_bf16 v[208:223], a[92:95], v[124:127], v[208:223]
  buffer_load_dwordx4 v[96:99], v242, s[20:23], s84 offen offset:2048 sc1
  s_nop 10
  v_pk_mul_f32 v[176:177], v[176:177], v[208:209]
  v_cvt_pk_bf16_f32 v208, v176, v177
  v_pk_mul_f32 v[178:179], v[178:179], v[210:211]
  v_cvt_pk_bf16_f32 v209, v178, v179
  v_pk_mul_f32 v[180:181], v[180:181], v[212:213]
  v_cvt_pk_bf16_f32 v210, v180, v181
  v_pk_mul_f32 v[182:183], v[182:183], v[214:215]
  v_cvt_pk_bf16_f32 v211, v182, v183
  v_pk_mul_f32 v[184:185], v[184:185], v[216:217]
  v_cvt_pk_bf16_f32 v212, v184, v185
  v_pk_mul_f32 v[186:187], v[186:187], v[218:219]
  v_cvt_pk_bf16_f32 v213, v186, v187
  v_pk_mul_f32 v[188:189], v[188:189], v[220:221]
  v_cvt_pk_bf16_f32 v214, v188, v189
  buffer_load_dwordx4 v[100:103], v243, s[20:23], s84 offen offset:2048 sc1
  v_pk_mul_f32 v[190:191], v[190:191], v[222:223]
  v_cvt_pk_bf16_f32 v215, v190, v191
  buffer_store_dwordx4 v[208:211], v1, s[20:23], s52 offen offset:2048 sc1
  buffer_store_dwordx4 v[212:215], v1, s[20:23], s52 offen offset:3072 sc1
  s_waitcnt vmcnt(15)
  v_xor_b32 v234, s58, v234
  v_xor_b32 v238, s58, v238
  v_ashrrev_i32 v235, 31, v240
  v_bfi_b32 v234, v235, 0, v234
  v_ashrrev_i32_e64 v235, 31, v241
  v_bfi_b32 v238, v235, 0, v238
  v_or_b32 v234, v234, v238
  v_cmp_ne_u32 vcc, 0, v234
  s_nop 1
  s_cbranch_vccnz L_E_spin
L_E_ok:
  ds_write_b64 v35, v[232:233]
  buffer_load_dwordx4 v[104:107], v242, s[20:23], s84 offen offset:3072 sc1
  ds_write_b64 v35, v[236:237] offset:256
  s_waitcnt lgkmcnt(0)
  s_barrier
  ds_read_b64 v[16:17], v34 offset:0
  ds_read_b64 v[18:19], v34 offset:256
  ds_read_b64 v[20:21], v34 offset:512
  ds_read_b64 v[22:23], v34 offset:768
  ds_read_b64 v[24:25], v34 offset:1024
  ds_read_b64 v[26:27], v34 offset:1280
  ds_read_b64 v[28:29], v34 offset:1536
  ds_read_b64 v[30:31], v34 offset:1792
  buffer_load_dwordx4 v[108:111], v243, s[20:23], s84 offen offset:3072 sc1
  s_waitcnt lgkmcnt(0)
  v_fmac_f32 v18, v6, v16
  v_fmac_f32_e64 v19, v6, v17
  v_fma_f32 v18, -v7, v17, v18
  v_fmac_f32_e64 v19, v7, v16
  v_fmac_f32 v20, v6, v18
  v_fmac_f32 v21, v6, v19
  v_fma_f32 v20, -v7, v19, v20
  v_fmac_f32_e64 v21, v7, v18
  v_fmac_f32 v22, v6, v20
  v_fmac_f32 v23, v6, v21
  v_fma_f32 v22, -v7, v21, v22
  v_fmac_f32 v23, v7, v20
  v_fmac_f32 v24, v6, v22
  s_add_u32 s84, s83, 8192
  buffer_load_dwordx4 v[112:115], v242, s[20:23], s84 offen offset:0 sc1
  v_fmac_f32_e64 v25, v6, v23
  v_fma_f32 v24, -v7, v23, v24
  v_fmac_f32_e64 v25, v7, v22
  v_fmac_f32 v26, v6, v24
  v_fmac_f32 v27, v6, v25
  v_fma_f32 v26, -v7, v25, v26
  v_fmac_f32_e64 v27, v7, v24
  v_fmac_f32 v28, v6, v26
  v_fmac_f32 v29, v6, v27
  v_fma_f32 v28, -v7, v27, v28
  v_fmac_f32_e64 v29, v7, v26
  v_fmac_f32 v30, v6, v28
  v_fmac_f32 v31, v6, v29
  v_fma_f32 v30, -v7, v29, v30
  buffer_load_dwordx4 v[116:119], v243, s[20:23], s84 offen offset:0 sc1
  v_fmac_f32 v31, v7, v28
  v_mov_b32 v228, v30
  v_mov_b32 v229, v31
  s_nop 0
  v_permlane32_swap_b32 v30, v228
  v_permlane32_swap_b32 v31, v229
  v_fmac_f32 v228, v8, v30
  v_fmac_f32 v229, v8, v31
  v_fma_f32 v228, -v9, v31, v228
  v_fmac_f32 v229, v9, v30
  v_fmac_f32 v4, v15, v228
  v_fma_f32 v5, -v15, v229, v5
  v_fma_f32 v4, -v251, v229, v4
  v_fma_f32 v5, -v251, v228, v5
  s_add_u32 m0, s42, 86016
  s_nop 0
  buffer_load_dwordx4 v244, s[96:99], s86 offen offset:0 lds
  v_fmac_f32 v128, v2, v4
  v_fmac_f32 v144, v2, v5
  v_fmac_f32 v128, v3, v5
  v_fma_f32 v144, -v3, v4, v144
  v_fmac_f32_e64 v129, v2, v128
  v_fmac_f32 v145, v2, v144
  v_fmac_f32 v129, v3, v144
  v_fma_f32 v145, -v3, v128, v145
  v_cvt_pk_bf16_f32 v16, v128, v129
  v_cvt_pk_bf16_f32 v24, v144, v145
  v_fmac_f32_e64 v130, v2, v129
  v_fmac_f32 v146, v2, v145
  v_fmac_f32 v130, v3, v145
  v_fma_f32 v146, -v3, v129, v146
  s_add_u32 m0, s42, 89984
  s_nop 0
  buffer_load_dwordx4 v244, s[96:99], s86 offen offset:128 lds
  v_fmac_f32 v131, v2, v130
  v_fmac_f32 v147, v2, v146
  v_fmac_f32 v131, v3, v146
  v_fma_f32 v147, -v3, v130, v147
  v_cvt_pk_bf16_f32 v17, v130, v131
  v_cvt_pk_bf16_f32 v25, v146, v147
  v_fmac_f32_e64 v132, v2, v131
  v_fmac_f32 v148, v2, v147
  v_fmac_f32 v132, v3, v147
  v_fma_f32 v148, -v3, v131, v148
  v_fmac_f32_e64 v133, v2, v132
  v_fmac_f32 v149, v2, v148
  v_fmac_f32 v133, v3, v148
  v_fma_f32 v149, -v3, v132, v149
  s_add_u32 m0, s42, 93952
  s_nop 0
  buffer_load_dwordx4 v244, s[96:99], s86 offen offset:256 lds
  v_cvt_pk_bf16_f32 v18, v132, v133
  v_cvt_pk_bf16_f32 v26, v148, v149
  v_fmac_f32 v134, v2, v133
  v_fmac_f32 v150, v2, v149
  v_fmac_f32 v134, v3, v149
  v_fma_f32 v150, -v3, v133, v150
  v_fmac_f32_e64 v135, v2, v134
  v_fmac_f32 v151, v2, v150
  v_fmac_f32 v135, v3, v150
  v_fma_f32 v151, -v3, v134, v151
  v_cvt_pk_bf16_f32 v19, v134, v135
  v_cvt_pk_bf16_f32 v27, v150, v151
  v_fmac_f32_e64 v136, v2, v135
  v_fmac_f32 v152, v2, v151
  s_waitcnt vmcnt(7)
  s_add_u32 s59, s54, 8192
  s_atomic_add s5, s[20:21], s59
  buffer_load_dwordx4 v[120:123], v242, s[20:23], s84 offen offset:1024 sc1
  v_fmac_f32_e64 v136, v3, v151
  v_fma_f32 v152, -v3, v135, v152
  v_fmac_f32_e64 v137, v2, v136
  v_fmac_f32 v153, v2, v152
  v_fmac_f32 v137, v3, v152
  v_fma_f32 v153, -v3, v136, v153
  v_cvt_pk_bf16_f32 v20, v136, v137
  v_cvt_pk_bf16_f32 v28, v152, v153
  v_fmac_f32_e64 v138, v2, v137
  v_fmac_f32 v154, v2, v153
  v_fmac_f32 v138, v3, v153
  v_fma_f32 v154, -v3, v137, v154
  v_fmac_f32 v139, v2, v138
  v_fmac_f32 v155, v2, v154
  buffer_load_dwordx4 v[124:127], v243, s[20:23], s84 offen offset:1024 sc1
  v_fmac_f32_e64 v139, v3, v154
  v_fma_f32 v155, -v3, v138, v155
  v_cvt_pk_bf16_f32 v21, v138, v139
  v_cvt_pk_bf16_f32 v29, v154, v155
  v_fmac_f32_e64 v140, v2, v139
  v_fmac_f32 v156, v2, v155
  v_fmac_f32 v140, v3, v155
  v_fma_f32 v156, -v3, v139, v156
  v_fmac_f32_e64 v141, v2, v140
  v_fmac_f32 v157, v2, v156
  v_fmac_f32 v141, v3, v156
  v_fma_f32 v157, -v3, v140, v157
  v_cvt_pk_bf16_f32 v22, v140, v141
  v_cvt_pk_bf16_f32 v30, v156, v157
  s_add_u32 m0, s42, 97920
  s_nop 0
  buffer_load_dwordx4 v244, s[96:99], s86 offen offset:384 lds
  v_fmac_f32 v142, v2, v141
  v_fmac_f32 v158, v2, v157
  v_fmac_f32 v142, v3, v157
  v_fma_f32 v158, -v3, v141, v158
  v_fmac_f32_e64 v143, v2, v142
  v_fmac_f32 v159, v2, v158
  v_fmac_f32 v143, v3, v158
  v_fma_f32 v159, -v3, v142, v159
  v_cvt_pk_bf16_f32 v23, v142, v143
  v_cvt_pk_bf16_f32 v31, v158, v159
  ds_write_b128 v32, v[16:19] offset:0
  ds_write_b128 v32, v[20:23] offset:16
  ds_write_b128 v32, v[24:27] offset:2560
  ds_write_b128 v32, v[28:31] offset:2576
  s_add_u32 m0, s42, 101888
  s_nop 0
  buffer_load_dwordx4 v244, s[96:99], s86 offen offset:512 lds
  ds_read_b64_tr_b16 v[128:129], v33 offset:0
  ds_read_b64_tr_b16 v[130:131], v33 offset:320
  ds_read_b64_tr_b16 v[132:133], v33 offset:1280
  ds_read_b64_tr_b16 v[134:135], v33 offset:1600
  ds_read_b64_tr_b16 v[136:137], v33 offset:2560
  ds_read_b64_tr_b16 v[138:139], v33 offset:2880
  ds_read_b64_tr_b16 v[140:141], v33 offset:3840
  ds_read_b64_tr_b16 v[142:143], v33 offset:4160
  s_add_u32 m0, s42, 105856
  s_nop 0
  buffer_load_dwordx4 v244, s[96:99], s86 offen offset:640 lds
  ds_read_b32 v46, v1
  s_waitcnt lgkmcnt(1)
  buffer_store_dwordx4 v[128:131], v1, s[20:23], s53 offen offset:0 sc1
  buffer_store_dwordx4 v[132:135], v1, s[20:23], s53 offen offset:1024 sc1
  buffer_store_dwordx4 v[136:139], v1, s[20:23], s82 offen offset:0 sc1
  buffer_store_dwordx4 v[140:143], v1, s[20:23], s82 offen offset:1024 sc1
  s_lshr_b32 s47, s3, 1
  s_lshl_b32 s48, s60, 1
  s_add_u32 s47, s47, s48
  s_lshl_b32 s47, s47, 5
  s_lshl_b32 s48, s7, 1
  s_add_u32 s48, s48, s46
  s_lshl_b32 s48, s48, 5
  s_movk_i32 s44, 448
  v_lshrrev_b32 v233, 5, v0
  v_lshl_add_u32 v40, v233, 4, s47
  v_and_b32 v232, 31, v0
  v_add_u32 v41, s48, v232
  v_mfma_f32_32x32x16_bf16 v[160:175], v[48:51], a[96:99], 0
  v_mul_u32_u24_e64 v40, s44, v40
  v_add_lshl_u32 v40, v40, v41, 2
  v_lshlrev_b32 v41, 1, v41
  v_lshlrev_b32 v42, 10, v233
  v_lshl_add_u32 v42, v232, 1, v42
  v_mfma_f32_32x32x16_bf16 v[176:191], v[48:51], a[100:103], 0
  s_add_u32 s51, s80, 5120
  v_add_u32_e64 v42, s51, v42
  s_add_u32 s43, s80, 8192
  v_lshl_add_u32 v43, v233, 7, s43
  v_lshrrev_b32_e64 v44, 2, v0
  v_mfma_f32_32x32x16_bf16 v[192:207], v[52:55], a[96:99], 0
  s_movk_i32 s43, 896
  v_mul_u32_u24 v44, s43, v44
  v_and_b32_e64 v232, 3, v0
  v_lshl_add_u32 v44, v232, 4, v44
  s_lshl_b32 s48, s48, 1
  v_mfma_f32_32x32x16_bf16 v[208:223], v[52:55], a[100:103], 0
  s_mul_i32 s50, s47, 896
  s_add_u32 s50, s50, s48
  s_lshl_b32 s47, s47, 3
  s_add_u32 s47, s47, 11010048
  v_lshlrev_b32 v45, 2, v0
  buffer_load_dwordx4 v[48:51], v242, s[20:23], s84 offen offset:2048 sc1
  v_mfma_f32_32x32x16_bf16 v[160:175], v[56:59], a[104:107], v[160:175]
  global_load_ushort v41, v41, s[56:57]
  s_mul_i32 s55, s60, 336
  s_mul_i32 s43, s46, 28
  s_add_u32 s55, s55, s43
  s_add_u32 s55, s55, 112
  v_mfma_f32_32x32x16_bf16 v[176:191], v[56:59], a[108:111], v[176:191]
  s_lshl_b32 s55, s55, 10
  s_mul_i32 s43, s46, 57344
  s_sub_u32 s43, s43, 86016
  v_add_u32 v245, s43, v245
  v_add_u32_e64 v246, s43, v246
  buffer_load_dwordx4 v[52:55], v243, s[20:23], s84 offen offset:2048 sc1
  v_mfma_f32_32x32x16_bf16 v[192:207], v[60:63], a[104:107], v[192:207]
  v_add_u32_e64 v247, s43, v247
  v_add_u32 v248, s43, v248
  v_mov_b32 v16, 0
  v_mov_b32 v17, 0
  v_mov_b32 v18, 0
  v_mfma_f32_32x32x16_bf16 v[208:223], v[60:63], a[108:111], v[208:223]
  v_mov_b32_e64 v19, 0
  v_mov_b32 v20, 0
  v_mov_b32 v21, 0
  v_mov_b32 v22, 0
  v_mov_b32 v23, 0
  s_add_u32 s4, s85, 8192
  s_add_u32 s30, s85, 8320
  s_load_dword s100, s[20:21], s4 glc
  s_load_dword s101, s[20:21], s30 glc
  s_add_u32 m0, s42, 109824
  s_nop 0
  buffer_load_dwordx4 v244, s[96:99], s86 offen offset:768 lds
  v_mfma_f32_32x32x16_bf16 v[160:175], v[64:67], a[112:115], v[160:175]
  v_mov_b32 v24, 0
  v_mov_b32 v25, 0
  v_mov_b32 v26, 0
  v_mov_b32 v27, 0
  v_mov_b32 v28, 0
  v_mfma_f32_32x32x16_bf16 v[176:191], v[64:67], a[116:119], v[176:191]
  v_mov_b32_e64 v29, 0
  v_mov_b32 v30, 0
  v_mov_b32 v31, 0
  v_add_u32 v14, s80, v1
  s_lshl_b32 s43, s3, 11
  s_add_u32 m0, s42, 0
  s_nop 0
  buffer_load_dwordx4 v244, s[64:67], s86 offen offset:0 lds
  v_mfma_f32_32x32x16_bf16 v[192:207], v[68:71], a[112:115], v[192:207]
  s_add_u32 s43, s43, 155648
  v_add_u32 v15, s43, v1
  s_xor_b32 s43, s3, 1
  s_mul_i32 s44, s43, 10240
  s_add_u32 s44, s44, 114688
  v_mfma_f32_32x32x16_bf16 v[208:223], v[68:71], a[116:119], v[208:223]
  v_add_u32 v5, s44, v1
  s_xor_b32 s43, s3, 2
  s_mul_i32 s44, s43, 10240
  s_add_u32 s44, s44, 118784
  v_add_u32_e64 v6, s44, v1
  s_add_u32 m0, s42, 3968
  s_nop 0
  buffer_load_dwordx4 v244, s[64:67], s86 offen offset:128 lds
  v_mfma_f32_32x32x16_bf16 v[160:175], v[72:75], a[120:123], v[160:175]
  s_xor_b32 s43, s3, 3
  s_mul_i32 s44, s43, 10240
  s_add_u32 s44, s44, 122880
  v_add_u32 v7, s44, v1
  s_lshl_b32 s44, s43, 11
  v_mfma_f32_32x32x16_bf16 v[176:191], v[72:75], a[124:127], v[176:191]
  s_add_u32 s44, s44, 155648
  v_add_u32_e64 v8, s44, v1
  s_mov_b32 s44, 0xbfb8aa3b
  buffer_load_dwordx4 v[56:59], v242, s[20:23], s84 offen offset:3072 sc1
  v_mfma_f32_32x32x16_bf16 v[192:207], v[76:79], a[120:123], v[192:207]
  v_mfma_f32_32x32x16_bf16 v[208:223], v[76:79], a[124:127], v[208:223]
  buffer_load_dwordx4 v[60:63], v243, s[20:23], s84 offen offset:3072 sc1
  v_mfma_f32_32x32x16_bf16 v[160:175], v[80:83], a[128:131], v[160:175]
  v_mfma_f32_32x32x16_bf16 v[176:191], v[80:83], a[132:135], v[176:191]
  s_add_u32 m0, s42, 7936
  s_nop 0
  buffer_load_dwordx4 v244, s[64:67], s86 offen offset:256 lds
  v_mfma_f32_32x32x16_bf16 v[192:207], v[84:87], a[128:131], v[192:207]
  v_mfma_f32_32x32x16_bf16 v[208:223], v[84:87], a[132:135], v[208:223]
  s_add_u32 m0, s42, 11904
  s_nop 0
  buffer_load_dwordx4 v244, s[64:67], s86 offen offset:384 lds
  v_mfma_f32_32x32x16_bf16 v[160:175], v[88:91], a[136:139], v[160:175]
  v_mfma_f32_32x32x16_bf16 v[176:191], v[88:91], a[140:143], v[176:191]
  s_waitcnt vmcnt(10)
  s_add_u32 s59, s54, 16384
  s_atomic_add s5, s[20:21], s59
  s_add_u32 m0, s42, 15872
  s_nop 0
  buffer_load_dwordx4 v244, s[64:67], s86 offen offset:512 lds
  v_mfma_f32_32x32x16_bf16 v[192:207], v[92:95], a[136:139], v[192:207]
  v_mfma_f32_32x32x16_bf16 v[208:223], v[92:95], a[140:143], v[208:223]
  s_add_u32 s84, s83, 12288
  buffer_load_dwordx4 v[64:67], v242, s[20:23], s84 offen offset:0 sc1
  v_mfma_f32_32x32x16_bf16 v[160:175], v[96:99], a[144:147], v[160:175]
  v_mfma_f32_32x32x16_bf16 v[176:191], v[96:99], a[148:151], v[176:191]
  buffer_load_dwordx4 v[68:71], v243, s[20:23], s84 offen offset:0 sc1
  v_mfma_f32_32x32x16_bf16 v[192:207], v[100:103], a[144:147], v[192:207]
  v_mfma_f32_32x32x16_bf16 v[208:223], v[100:103], a[148:151], v[208:223]
  s_add_u32 m0, s42, 19840
  s_nop 0
  buffer_load_dwordx4 v244, s[64:67], s86 offen offset:640 lds
  v_mfma_f32_32x32x16_bf16 v[160:175], v[104:107], a[152:155], v[160:175]
  v_mfma_f32_32x32x16_bf16 v[176:191], v[104:107], a[156:159], v[176:191]
  s_add_u32 m0, s42, 23808
  s_nop 0
  buffer_load_dwordx4 v244, s[64:67], s86 offen offset:768 lds
  v_mfma_f32_32x32x16_bf16 v[192:207], v[108:111], a[152:155], v[192:207]
  v_mfma_f32_32x32x16_bf16 v[208:223], v[108:111], a[156:159], v[208:223]
  buffer_load_dwordx4 v[72:75], v242, s[20:23], s84 offen offset:1024 sc1
  v_mfma_f32_32x32x16_bf16 v[160:175], v[112:115], a[160:163], v[160:175]
  v_mfma_f32_32x32x16_bf16 v[176:191], v[112:115], a[164:167], v[176:191]
  buffer_load_dwordx4 v[76:79], v243, s[20:23], s84 offen offset:1024 sc1
  v_mfma_f32_32x32x16_bf16 v[192:207], v[116:119], a[160:163], v[192:207]
  v_mfma_f32_32x32x16_bf16 v[208:223], v[116:119], a[164:167], v[208:223]
  s_mov_b32 m0, s51
  s_nop 0
  buffer_load_dwordx4 v44, s[8:11], s50 offen lds
  s_add_u32 s50, s50, 13312
  v_mfma_f32_32x32x16_bf16 v[160:175], v[120:123], a[168:171], v[160:175]
  v_mfma_f32_32x32x16_bf16 v[176:191], v[120:123], a[172:175], v[176:191]
  buffer_load_dwordx4 v44, s[8:11], s50 offen offset:1024 lds
  v_mfma_f32_32x32x16_bf16 v[192:207], v[124:127], a[168:171], v[192:207]
  v_mfma_f32_32x32x16_bf16 v[208:223], v[124:127], a[172:175], v[208:223]
  s_add_u32 m0, s80, 8192
  s_nop 0
  buffer_load_dword v45, s[20:23], s47 offen sc1 lds
  s_waitcnt vmcnt(17)
  v_mfma_f32_32x32x16_bf16 v[160:175], v[48:51], a[176:179], v[160:175]
  v_mfma_f32_32x32x16_bf16 v[176:191], v[48:51], a[180:183], v[176:191]
  s_waitcnt lgkmcnt(0)
  s_add_u32 s100, s100, s101
  s_cmp_eq_u32 s100, 28
  s_cbranch_scc0 L_f1_spin
L_f1_ok:
  s_add_u32 s84, s83, 57344
  buffer_load_dwordx4 v[80:83], v242, s[20:23], s84 offen offset:0 sc1
  v_mfma_f32_32x32x16_bf16 v[192:207], v[52:55], a[176:179], v[192:207]
  v_mfma_f32_32x32x16_bf16 v[208:223], v[52:55], a[180:183], v[208:223]
  buffer_load_dwordx4 v[84:87], v243, s[20:23], s84 offen offset:0 sc1
  s_waitcnt vmcnt(14)
  v_mfma_f32_32x32x16_bf16 v[160:175], v[56:59], a[184:187], v[160:175]
  v_mfma_f32_32x32x16_bf16 v[176:191], v[56:59], a[188:191], v[176:191]
  buffer_load_dwordx4 v[88:91], v242, s[20:23], s84 offen offset:1024 sc1
  v_mfma_f32_32x32x16_bf16 v[192:207], v[60:63], a[184:187], v[192:207]
  v_mfma_f32_32x32x16_bf16 v[208:223], v[60:63], a[188:191], v[208:223]
  buffer_load_dwordx4 v[92:95], v243, s[20:23], s84 offen offset:1024 sc1
  s_waitcnt vmcnt(11)
  v_mfma_f32_32x32x16_bf16 v[160:175], v[64:67], a[192:195], v[160:175]
  v_mfma_f32_32x32x16_bf16 v[176:191], v[64:67], a[196:199], v[176:191]
  buffer_load_dwordx4 v[96:99], v242, s[20:23], s84 offen offset:2048 sc1
  v_mfma_f32_32x32x16_bf16 v[192:207], v[68:71], a[192:195], v[192:207]
  v_mfma_f32_32x32x16_bf16 v[208:223], v[68:71], a[196:199], v[208:223]
  buffer_load_dwordx4 v[100:103], v243, s[20:23], s84 offen offset:2048 sc1
  buffer_load_dwordx4 v[104:107], v242, s[20:23], s84 offen offset:3072 sc1
  s_waitcnt vmcnt(10)
  v_mfma_f32_32x32x16_bf16 v[160:175], v[72:75], a[200:203], v[160:175]
  v_mfma_f32_32x32x16_bf16 v[176:191], v[72:75], a[204:207], v[176:191]
  buffer_load_dwordx4 v[108:111], v243, s[20:23], s84 offen offset:3072 sc1
  v_mfma_f32_32x32x16_bf16 v[192:207], v[76:79], a[200:203], v[192:207]
  s_waitcnt vmcnt(8)
  v_lshlrev_b32_e64 v41, 16, v41
  ds_read_u16_d16_hi v16, v42 offset:0
  ds_read_u16_d16_hi v17, v42 offset:64
  ds_read_u16_d16_hi v18, v42 offset:128
  v_mfma_f32_32x32x16_bf16 v[208:223], v[76:79], a[204:207], v[208:223]
  ds_read_u16_d16_hi v19, v42 offset:192
  ds_read_u16_d16_hi v20, v42 offset:256
  ds_read_u16_d16_hi v21, v42 offset:320
  ds_read_u16_d16_hi v22, v42 offset:384
  ds_read_u16_d16_hi v23, v42 offset:448
  s_add_u32 s84, s83, 61440
  buffer_load_dwordx4 v[112:115], v242, s[20:23], s84 offen offset:0 sc1
  ds_read_u16_d16_hi v24, v42 offset:512
  ds_read_u16_d16_hi v25, v42 offset:576
  ds_read_u16_d16_hi v26, v42 offset:640
  ds_read_u16_d16_hi v27, v42 offset:704
  ds_read_u16_d16_hi v28, v42 offset:768
  ds_read_u16_d16_hi v29, v42 offset:832
  ds_read_u16_d16_hi v30, v42 offset:896
  ds_read_u16_d16_hi v31, v42 offset:960
  ds_read_b128 v[128:131], v43 offset:0
  ds_read_b128 v[132:135], v43 offset:16
  ds_read_b128 v[136:139], v43 offset:32
  ds_read_b128 v[140:143], v43 offset:48
  ds_read_b128 v[144:147], v43 offset:64
  ds_read_b128 v[148:151], v43 offset:80
  ds_read_b128 v[152:155], v43 offset:96
  ds_read_b128 v[156:159], v43 offset:112
  buffer_load_dwordx4 v[116:119], v243, s[20:23], s84 offen offset:0 sc1
  buffer_load_dwordx4 v[120:123], v242, s[20:23], s84 offen offset:1024 sc1
  buffer_load_dwordx4 v[124:127], v243, s[20:23], s84 offen offset:1024 sc1
  s_waitcnt vmcnt(10)
  v_mfma_f32_32x32x16_bf16 v[160:175], v[80:83], a[208:211], v[160:175]
  s_waitcnt lgkmcnt(0)
  v_sub_f32 v128, v16, v128
  v_sub_f32 v130, v17, v130
  v_sub_f32 v132, v18, v132
  v_sub_f32 v134, v19, v134
  v_mfma_f32_32x32x16_bf16 v[176:191], v[80:83], a[212:215], v[176:191]
  v_sub_f32_e64 v136, v20, v136
  v_sub_f32 v138, v21, v138
  v_sub_f32 v140, v22, v140
  v_sub_f32 v142, v23, v142
  v_sub_f32 v144, v24, v144
  buffer_load_dwordx4 v[48:51], v242, s[20:23], s84 offen offset:2048 sc1
  v_mfma_f32_32x32x16_bf16 v[192:207], v[84:87], a[208:211], v[192:207]
  v_sub_f32_e64 v146, v25, v146
  v_sub_f32 v148, v26, v148
  v_sub_f32 v150, v27, v150
  v_sub_f32 v152, v28, v152
  v_sub_f32 v154, v29, v154
  v_mfma_f32_32x32x16_bf16 v[208:223], v[84:87], a[212:215], v[208:223]
  v_sub_f32_e64 v156, v30, v156
  v_sub_f32 v158, v31, v158
  v_mul_f32 v128, v128, v129
  v_mul_f32 v129, v129, v129
  v_mul_f32 v130, v130, v131
  buffer_load_dwordx4 v[52:55], v243, s[20:23], s84 offen offset:2048 sc1
  s_waitcnt vmcnt(10)
  v_mfma_f32_32x32x16_bf16 v[160:175], v[88:91], a[216:219], v[160:175]
  v_mul_f32 v131, v131, v131
  v_mul_f32 v132, v132, v133
  v_mul_f32 v133, v133, v133
  v_mul_f32 v134, v134, v135
  v_mul_f32 v135, v135, v135
  v_mfma_f32_32x32x16_bf16 v[176:191], v[88:91], a[220:223], v[176:191]
  v_mul_f32_e64 v136, v136, v137
  v_mul_f32 v137, v137, v137
  v_mul_f32 v138, v138, v139
  v_mul_f32 v139, v139, v139
  v_mul_f32 v140, v140, v141
  s_add_u32 s4, s85, 16384
  s_add_u32 s30, s85, 16512
  s_load_dword s100, s[20:21], s4 glc
  s_load_dword s101, s[20:21], s30 glc
  buffer_load_dwordx4 v[56:59], v242, s[20:23], s84 offen offset:3072 sc1
  v_mfma_f32_32x32x16_bf16 v[192:207], v[92:95], a[216:219], v[192:207]
  v_mul_f32_e64 v141, v141, v141
  v_mul_f32 v142, v142, v143
  v_mul_f32 v143, v143, v143
  v_mul_f32 v144, v144, v145
  v_mul_f32 v145, v145, v145
  v_mfma_f32_32x32x16_bf16 v[208:223], v[92:95], a[220:223], v[208:223]
  v_mul_f32_e64 v146, v146, v147
  v_mul_f32 v147, v147, v147
  v_mul_f32 v148, v148, v149
  v_mul_f32 v149, v149, v149
  v_mul_f32 v150, v150, v151
  buffer_load_dwordx4 v[60:63], v243, s[20:23], s84 offen offset:3072 sc1
  s_waitcnt vmcnt(10)
  v_mfma_f32_32x32x16_bf16 v[160:175], v[96:99], a[224:227], v[160:175]
  v_mul_f32 v151, v151, v151
  v_mul_f32 v152, v152, v153
  v_mul_f32 v153, v153, v153
  v_mul_f32 v154, v154, v155
  v_mul_f32 v155, v155, v155
  v_mfma_f32_32x32x16_bf16 v[176:191], v[96:99], a[228:231], v[176:191]
  v_mul_f32_e64 v156, v156, v157
  v_mul_f32 v157, v157, v157
  v_mul_f32 v158, v158, v159
  v_mul_f32 v159, v159, v159
  v_mul_f32 v128, v128, v41
  s_add_u32 s84, s83, 65536
  buffer_load_dwordx4 v[64:67], v242, s[20:23], s84 offen offset:0 sc1
  v_mfma_f32_32x32x16_bf16 v[192:207], v[100:103], a[224:227], v[192:207]
  v_mul_f32_e64 v130, v130, v41
  v_mul_f32 v132, v132, v41
  v_mul_f32 v134, v134, v41
  v_mul_f32 v136, v136, v41
  v_mul_f32 v138, v138, v41
  v_mfma_f32_32x32x16_bf16 v[208:223], v[100:103], a[228:231], v[208:223]
  v_mul_f32_e64 v140, v140, v41
  v_mul_f32 v142, v142, v41
  v_mul_f32 v144, v144, v41
  v_mul_f32 v146, v146, v41
  v_mul_f32 v148, v148, v41
  buffer_load_dwordx4 v[68:71], v243, s[20:23], s84 offen offset:0 sc1
  s_waitcnt vmcnt(10)
  v_mfma_f32_32x32x16_bf16 v[160:175], v[104:107], a[232:235], v[160:175]
  v_mul_f32 v150, v150, v41
  v_mul_f32 v152, v152, v41
  v_mul_f32 v154, v154, v41
  v_mul_f32 v156, v156, v41
  v_mul_f32 v158, v158, v41
  v_mfma_f32_32x32x16_bf16 v[176:191], v[104:107], a[236:239], v[176:191]
  s_barrier
  buffer_load_dwordx4 v[72:75], v242, s[20:23], s84 offen offset:1024 sc1
  v_mfma_f32_32x32x16_bf16 v[192:207], v[108:111], a[232:235], v[192:207]
  ds_read_b128 a[64:67], v245 offset:0
  ds_read_b128 a[68:71], v245 offset:28672
  v_mfma_f32_32x32x16_bf16 v[208:223], v[108:111], a[236:239], v[208:223]
  ds_read_b128 a[72:75], v246 offset:0
  ds_read_b128 a[76:79], v246 offset:28672
  buffer_load_dwordx4 v[76:79], v243, s[20:23], s84 offen offset:1024 sc1
  s_waitcnt vmcnt(10)
  v_mfma_f32_32x32x16_bf16 v[160:175], v[112:115], a[240:243], v[160:175]
  ds_read_b128 a[80:83], v247 offset:0
  ds_read_b128 a[84:87], v247 offset:28672
  v_mfma_f32_32x32x16_bf16 v[176:191], v[112:115], a[244:247], v[176:191]
  ds_read_b128 a[88:91], v248 offset:0
  ds_read_b128 a[92:95], v248 offset:28672
  buffer_load_dwordx4 v[80:83], v242, s[20:23], s84 offen offset:2048 sc1
  v_mfma_f32_32x32x16_bf16 v[192:207], v[116:119], a[240:243], v[192:207]
  ds_read_b128 a[128:131], v245 offset:4096
  ds_read_b128 a[132:135], v245 offset:32768
  v_mfma_f32_32x32x16_bf16 v[208:223], v[116:119], a[244:247], v[208:223]
  ds_read_b128 a[136:139], v246 offset:4096
  ds_read_b128 a[140:143], v246 offset:32768
  buffer_load_dwordx4 v[84:87], v243, s[20:23], s84 offen offset:2048 sc1
  s_waitcnt vmcnt(10)
  v_mfma_f32_32x32x16_bf16 v[160:175], v[120:123], a[248:251], v[160:175]
  ds_read_b128 a[144:147], v247 offset:4096
  ds_read_b128 a[148:151], v247 offset:32768
  v_mfma_f32_32x32x16_bf16 v[176:191], v[120:123], a[252:255], v[176:191]
  ds_read_b128 a[152:155], v248 offset:4096
  ds_read_b128 a[156:159], v248 offset:32768
  buffer_load_dwordx4 v[88:91], v242, s[20:23], s84 offen offset:3072 sc1
  v_mfma_f32_32x32x16_bf16 v[192:207], v[124:127], a[248:251], v[192:207]
  ds_read_b128 a[160:163], v245 offset:8192
  ds_read_b128 a[164:167], v245 offset:36864
  v_mfma_f32_32x32x16_bf16 v[208:223], v[124:127], a[252:255], v[208:223]
  ds_read_b128 a[168:171], v246 offset:8192
  ds_read_b128 a[172:175], v246 offset:36864
  buffer_load_dwordx4 v[92:95], v243, s[20:23], s84 offen offset:3072 sc1
  s_waitcnt vmcnt(10)
  v_mfma_f32_32x32x16_bf16 v[160:175], v[48:51], a[0:3], v[160:175]
  ds_read_b128 a[176:179], v247 offset:8192
  ds_read_b128 a[180:183], v247 offset:36864
  v_mfma_f32_32x32x16_bf16 v[176:191], v[48:51], a[4:7], v[176:191]
  ds_read_b128 a[184:187], v248 offset:8192
  ds_read_b128 a[188:191], v248 offset:36864
  s_add_u32 s84, s83, 69632
  buffer_load_dwordx4 v[96:99], v242, s[20:23], s84 offen offset:0 sc1
  v_mfma_f32_32x32x16_bf16 v[192:207], v[52:55], a[0:3], v[192:207]
  ds_read_b128 a[192:195], v245 offset:12288
  ds_read_b128 a[196:199], v245 offset:40960
  v_mfma_f32_32x32x16_bf16 v[208:223], v[52:55], a[4:7], v[208:223]
  ds_read_b128 a[200:203], v246 offset:12288
  ds_read_b128 a[204:207], v246 offset:40960
  buffer_load_dwordx4 v[100:103], v243, s[20:23], s84 offen offset:0 sc1
  s_waitcnt vmcnt(10)
  v_mfma_f32_32x32x16_bf16 v[160:175], v[56:59], a[8:11], v[160:175]
  ds_read_b128 a[208:211], v247 offset:12288
  ds_read_b128 a[212:215], v247 offset:40960
  v_mfma_f32_32x32x16_bf16 v[176:191], v[56:59], a[12:15], v[176:191]
  ds_read_b128 a[216:219], v248 offset:12288
  ds_read_b128 a[220:223], v248 offset:40960
  buffer_load_dwordx4 v[104:107], v242, s[20:23], s84 offen offset:1024 sc1
  v_mfma_f32_32x32x16_bf16 v[192:207], v[60:63], a[8:11], v[192:207]
  ds_read_b128 a[224:227], v245 offset:16384
  ds_read_b128 a[228:231], v245 offset:45056
  v_mfma_f32_32x32x16_bf16 v[208:223], v[60:63], a[12:15], v[208:223]
  ds_read_b128 a[232:235], v246 offset:16384
  ds_read_b128 a[236:239], v246 offset:45056
  buffer_load_dwordx4 v[108:111], v243, s[20:23], s84 offen offset:1024 sc1
  s_waitcnt vmcnt(10)
  v_mfma_f32_32x32x16_bf16 v[160:175], v[64:67], a[16:19], v[160:175]
  ds_read_b128 a[240:243], v247 offset:16384
  ds_read_b128 a[244:247], v247 offset:45056
  v_mfma_f32_32x32x16_bf16 v[176:191], v[64:67], a[20:23], v[176:191]
  ds_read_b128 a[248:251], v248 offset:16384
  ds_read_b128 a[252:255], v248 offset:45056
  s_waitcnt lgkmcnt(0)
  s_add_u32 s100, s100, s101
  s_cmp_eq_u32 s100, 28
  s_cbranch_scc0 L_f2_spin
L_f2_ok:
  s_add_u32 s84, s55, 0
  buffer_load_dwordx4 v[112:115], v242, s[20:23], s84 offen offset:0 sc1
  v_mfma_f32_32x32x16_bf16 v[192:207], v[68:71], a[16:19], v[192:207]
  ds_read_b128 a[0:3], v245 offset:20480
  ds_read_b128 a[4:7], v245 offset:49152
  v_mfma_f32_32x32x16_bf16 v[208:223], v[68:71], a[20:23], v[208:223]
  ds_read_b128 a[8:11], v246 offset:20480
  ds_read_b128 a[12:15], v246 offset:49152
  buffer_load_dwordx4 v[116:119], v242, s[20:23], s84 offen offset:1024 sc1
  s_waitcnt vmcnt(10)
  v_mfma_f32_32x32x16_bf16 v[160:175], v[72:75], a[24:27], v[160:175]
  v_mfma_f32_32x32x16_bf16 v[176:191], v[72:75], a[28:31], v[176:191]
  buffer_load_dwordx4 v[120:123], v242, s[20:23], s84 offen offset:2048 sc1
  v_mfma_f32_32x32x16_bf16 v[192:207], v[76:79], a[24:27], v[192:207]
  v_mfma_f32_32x32x16_bf16 v[208:223], v[76:79], a[28:31], v[208:223]
  buffer_load_dwordx4 v[124:127], v242, s[20:23], s84 offen offset:3072 sc1
  s_waitcnt vmcnt(10)
  v_mfma_f32_32x32x16_bf16 v[160:175], v[80:83], a[32:35], v[160:175]
  ds_read_b128 a[16:19], v247 offset:20480
  ds_read_b128 a[20:23], v247 offset:49152
  v_mfma_f32_32x32x16_bf16 v[176:191], v[80:83], a[36:39], v[176:191]
  ds_read_b128 a[24:27], v248 offset:20480
  ds_read_b128 a[28:31], v248 offset:49152
  s_add_u32 s84, s55, 4096
  buffer_load_dwordx4 v[48:51], v242, s[20:23], s84 offen offset:0 sc1
  v_mfma_f32_32x32x16_bf16 v[192:207], v[84:87], a[32:35], v[192:207]
  v_mfma_f32_32x32x16_bf16 v[208:223], v[84:87], a[36:39], v[208:223]
  buffer_load_dwordx4 v[52:55], v242, s[20:23], s84 offen offset:1024 sc1
  s_waitcnt vmcnt(10)
  v_mfma_f32_32x32x16_bf16 v[160:175], v[88:91], a[40:43], v[160:175]
  v_mfma_f32_32x32x16_bf16 v[176:191], v[88:91], a[44:47], v[176:191]
  buffer_load_dwordx4 v[56:59], v242, s[20:23], s84 offen offset:2048 sc1
  v_mfma_f32_32x32x16_bf16 v[192:207], v[92:95], a[40:43], v[192:207]
  v_mfma_f32_32x32x16_bf16 v[208:223], v[92:95], a[44:47], v[208:223]
  buffer_load_dwordx4 v[60:63], v242, s[20:23], s84 offen offset:3072 sc1
  s_waitcnt vmcnt(10)
  v_mfma_f32_32x32x16_bf16 v[160:175], v[96:99], a[48:51], v[160:175]
  ds_read_b128 a[32:35], v245 offset:24576
  ds_read_b128 a[36:39], v245 offset:53248
  v_mfma_f32_32x32x16_bf16 v[176:191], v[96:99], a[52:55], v[176:191]
  ds_read_b128 a[40:43], v246 offset:24576
  ds_read_b128 a[44:47], v246 offset:53248
  s_add_u32 s84, s55, 8192
  buffer_load_dwordx4 v[64:67], v242, s[20:23], s84 offen offset:0 sc1
  v_mfma_f32_32x32x16_bf16 v[192:207], v[100:103], a[48:51], v[192:207]
  v_mfma_f32_32x32x16_bf16 v[208:223], v[100:103], a[52:55], v[208:223]
  buffer_load_dwordx4 v[68:71], v242, s[20:23], s84 offen offset:1024 sc1
  s_waitcnt vmcnt(10)
  v_mfma_f32_32x32x16_bf16 v[160:175], v[104:107], a[56:59], v[160:175]
  v_mfma_f32_32x32x16_bf16 v[176:191], v[104:107], a[60:63], v[176:191]
  buffer_load_dwordx4 v[72:75], v242, s[20:23], s84 offen offset:2048 sc1
  v_mfma_f32_32x32x16_bf16 v[192:207], v[108:111], a[56:59], v[192:207]
  v_mfma_f32_32x32x16_bf16 v[208:223], v[108:111], a[60:63], v[208:223]
  buffer_load_dwordx4 v[76:79], v242, s[20:23], s84 offen offset:3072 sc1
  s_waitcnt vmcnt(10)
  v_mfma_f32_32x32x16_bf16 a[96:111], v[112:115], a[64:67], 0
  ds_read_b128 a[48:51], v247 offset:24576
  ds_read_b128 a[52:55], v247 offset:53248
  v_mfma_f32_32x32x16_bf16 a[112:127], v[112:115], a[68:71], 0
  ds_read_b128 a[56:59], v248 offset:24576
  ds_read_b128 a[60:63], v248 offset:53248
  s_add_u32 s84, s55, 12288
  buffer_load_dwordx4 v[80:83], v242, s[20:23], s84 offen offset:0 sc1
  v_mfma_f32_32x32x16_bf16 a[96:111], v[116:119], a[72:75], a[96:111]
  v_mfma_f32_32x32x16_bf16 a[112:127], v[116:119], a[76:79], a[112:127]
  ds_write_b128 v14, v[176:179] offset:0
  buffer_load_dwordx4 v[84:87], v242, s[20:23], s84 offen offset:1024 sc1
  s_waitcnt vmcnt(10)
  v_mfma_f32_32x32x16_bf16 a[96:111], v[120:123], a[80:83], a[96:111]
  ds_write_b128 v14, v[180:183] offset:1024
  v_mfma_f32_32x32x16_bf16 a[112:127], v[120:123], a[84:87], a[112:127]
  ds_write_b128 v14, v[184:187] offset:2048
  buffer_load_dwordx4 v[88:91], v242, s[20:23], s84 offen offset:2048 sc1
  v_mfma_f32_32x32x16_bf16 a[96:111], v[124:127], a[88:91], a[96:111]
  ds_write_b128 v14, v[188:191] offset:3072
  v_mfma_f32_32x32x16_bf16 a[112:127], v[124:127], a[92:95], a[112:127]
  ds_write_b128 v14, v[192:195] offset:4096
  buffer_load_dwordx4 v[92:95], v242, s[20:23], s84 offen offset:3072 sc1
  s_waitcnt vmcnt(10)
  v_mfma_f32_32x32x16_bf16 a[96:111], v[48:51], a[128:131], a[96:111]
  ds_write_b128 v14, v[196:199] offset:5120
  v_mfma_f32_32x32x16_bf16 a[112:127], v[48:51], a[132:135], a[112:127]
  ds_write_b128 v14, v[200:203] offset:6144
  s_add_u32 s84, s55, 16384
  buffer_load_dwordx4 v[96:99], v242, s[20:23], s84 offen offset:0 sc1
  v_mfma_f32_32x32x16_bf16 a[96:111], v[52:55], a[136:139], a[96:111]
  ds_write_b128 v14, v[204:207] offset:7168
  v_mfma_f32_32x32x16_bf16 a[112:127], v[52:55], a[140:143], a[112:127]
  ds_write_b128 v14, v[208:211] offset:8192
  buffer_load_dwordx4 v[100:103], v242, s[20:23], s84 offen offset:1024 sc1
  s_waitcnt vmcnt(10)
  v_mfma_f32_32x32x16_bf16 a[96:111], v[56:59], a[144:147], a[96:111]
  ds_write_b128 v14, v[212:215] offset:9216
  v_mfma_f32_32x32x16_bf16 a[112:127], v[56:59], a[148:151], a[112:127]
  ds_write_b128 v15, v[216:219] offset:0
  buffer_load_dwordx4 v[104:107], v242, s[20:23], s84 offen offset:2048 sc1
  v_mfma_f32_32x32x16_bf16 a[96:111], v[60:63], a[152:155], a[96:111]
  ds_write_b128 v15, v[220:223] offset:1024
  v_mfma_f32_32x32x16_bf16 a[112:127], v[60:63], a[156:159], a[112:127]
  buffer_load_dwordx4 v[108:111], v242, s[20:23], s84 offen offset:3072 sc1
  s_waitcnt vmcnt(10)
  v_mfma_f32_32x32x16_bf16 a[96:111], v[64:67], a[160:163], a[96:111]
  v_mfma_f32_32x32x16_bf16 a[112:127], v[64:67], a[164:167], a[112:127]
  s_add_u32 s84, s55, 20480
  buffer_load_dwordx4 v[112:115], v242, s[20:23], s84 offen offset:0 sc1
  v_mfma_f32_32x32x16_bf16 a[96:111], v[68:71], a[168:171], a[96:111]
  v_mfma_f32_32x32x16_bf16 a[112:127], v[68:71], a[172:175], a[112:127]
  s_waitcnt lgkmcnt(0)
  s_barrier
  ds_read_b128 v[176:179], v5 offset:0
  ds_read_b128 v[180:183], v5 offset:1024
  ds_read_b128 v[184:187], v5 offset:2048
  ds_read_b128 v[188:191], v5 offset:3072
  buffer_load_dwordx4 v[116:119], v242, s[20:23], s84 offen offset:1024 sc1
  s_waitcnt vmcnt(10)
  v_mfma_f32_32x32x16_bf16 a[96:111], v[72:75], a[176:179], a[96:111]
  ds_read_b128 v[192:195], v6 offset:0
  ds_read_b128 v[196:199], v6 offset:1024
  ds_read_b128 v[200:203], v6 offset:2048
  ds_read_b128 v[204:207], v6 offset:3072
  ds_read_b128 v[208:211], v7 offset:0
  v_mfma_f32_32x32x16_bf16 a[112:127], v[72:75], a[180:183], a[112:127]
  ds_read_b128 v[212:215], v7 offset:1024
  ds_read_b128 v[216:219], v8 offset:0
  ds_read_b128 v[220:223], v8 offset:1024
  buffer_load_dwordx4 v[120:123], v242, s[20:23], s84 offen offset:2048 sc1
  v_mfma_f32_32x32x16_bf16 a[96:111], v[76:79], a[184:187], a[96:111]
  s_waitcnt lgkmcnt(8)
  v_add_f32 v160, v160, v176
  v_add_f32_e64 v161, v161, v177
  v_add_f32 v162, v162, v178
  v_add_f32 v163, v163, v179
  v_mfma_f32_32x32x16_bf16 a[112:127], v[76:79], a[188:191], a[112:127]
  v_add_f32_e64 v164, v164, v180
  v_add_f32 v165, v165, v181
  v_add_f32 v166, v166, v182
  v_add_f32 v167, v167, v183
  v_add_f32 v168, v168, v184
  buffer_load_dwordx4 v[124:127], v242, s[20:23], s84 offen offset:3072 sc1
  s_waitcnt vmcnt(10)
  v_mfma_f32_32x32x16_bf16 a[96:111], v[80:83], a[192:195], a[96:111]
  v_add_f32 v169, v169, v185
  v_add_f32 v170, v170, v186
  v_add_f32 v171, v171, v187
  v_add_f32 v172, v172, v188
  v_add_f32 v173, v173, v189
  v_mfma_f32_32x32x16_bf16 a[112:127], v[80:83], a[196:199], a[112:127]
  v_add_f32_e64 v174, v174, v190
  v_add_f32 v175, v175, v191
  s_waitcnt lgkmcnt(4)
  v_add_f32 v160, v160, v192
  v_add_f32 v161, v161, v193
  s_add_u32 s84, s55, 24576
  buffer_load_dwordx4 v[48:51], v242, s[20:23], s84 offen offset:0 sc1
  v_mfma_f32_32x32x16_bf16 a[96:111], v[84:87], a[200:203], a[96:111]
  v_add_f32_e64 v162, v162, v194
  v_add_f32 v163, v163, v195
  v_add_f32 v164, v164, v196
  v_add_f32 v165, v165, v197
  v_add_f32 v166, v166, v198
  v_mfma_f32_32x32x16_bf16 a[112:127], v[84:87], a[204:207], a[112:127]
  v_add_f32_e64 v167, v167, v199
  v_add_f32 v168, v168, v200
  v_add_f32 v169, v169, v201
  v_add_f32 v170, v170, v202
  v_add_f32 v171, v171, v203
  buffer_load_dwordx4 v[52:55], v242, s[20:23], s84 offen offset:1024 sc1
  s_waitcnt vmcnt(10)
  v_mfma_f32_32x32x16_bf16 a[96:111], v[88:91], a[208:211], a[96:111]
  v_add_f32 v172, v172, v204
  v_add_f32 v173, v173, v205
  v_add_f32 v174, v174, v206
  v_add_f32 v175, v175, v207
  s_waitcnt lgkmcnt(0)
  v_mfma_f32_32x32x16_bf16 a[112:127], v[88:91], a[212:215], a[112:127]
  v_add_f32_e64 v160, v160, v208
  v_add_f32 v161, v161, v209
  v_add_f32 v162, v162, v210
  v_add_f32 v163, v163, v211
  v_add_f32 v164, v164, v212
  buffer_load_dwordx4 v[56:59], v242, s[20:23], s84 offen offset:2048 sc1
  v_mfma_f32_32x32x16_bf16 a[96:111], v[92:95], a[216:219], a[96:111]
  v_add_f32_e64 v165, v165, v213
  v_add_f32 v166, v166, v214
  v_add_f32 v167, v167, v215
  v_add_f32 v168, v168, v216
  v_add_f32 v169, v169, v217
  v_mfma_f32_32x32x16_bf16 a[112:127], v[92:95], a[220:223], a[112:127]
  v_add_f32_e64 v170, v170, v218
  v_add_f32 v171, v171, v219
  v_add_f32 v172, v172, v220
  v_add_f32 v173, v173, v221
  v_add_f32 v174, v174, v222
  buffer_load_dwordx4 v[60:63], v242, s[20:23], s84 offen offset:3072 sc1
  s_waitcnt vmcnt(10)
  v_mfma_f32_32x32x16_bf16 a[96:111], v[96:99], a[224:227], a[96:111]
  v_add_f32 v175, v175, v223
  v_mul_f32 v160, v160, v129
  v_mul_f32 v161, v161, v131
  v_mul_f32 v162, v162, v133
  v_mul_f32 v163, v163, v135
  v_mfma_f32_32x32x16_bf16 a[112:127], v[96:99], a[228:231], a[112:127]
  v_mul_f32_e64 v164, v164, v137
  v_mul_f32 v165, v165, v139
  v_mul_f32 v166, v166, v141
  v_mul_f32 v167, v167, v143
  v_mul_f32 v168, v168, v145
  v_mfma_f32_32x32x16_bf16 a[96:111], v[100:103], a[232:235], a[96:111]
  v_mul_f32_e64 v169, v169, v147
  v_mul_f32 v170, v170, v149
  v_mul_f32 v171, v171, v151
  v_mul_f32 v172, v172, v153
  v_mul_f32 v173, v173, v155
  v_mfma_f32_32x32x16_bf16 a[112:127], v[100:103], a[236:239], a[112:127]
  v_mul_f32 v174, v174, v157
  v_mul_f32 v175, v175, v159
  v_mul_f32 v176, s44, v160
  v_mul_f32 v177, s44, v161
  v_mul_f32 v178, s44, v162
  s_waitcnt vmcnt(8)
  v_mfma_f32_32x32x16_bf16 a[96:111], v[104:107], a[240:243], a[96:111]
  v_mul_f32_e64 v179, s44, v163
  v_mul_f32 v180, s44, v164
  v_mul_f32 v181, s44, v165
  v_mul_f32 v182, s44, v166
  v_mul_f32 v183, s44, v167
  v_mfma_f32_32x32x16_bf16 a[112:127], v[104:107], a[244:247], a[112:127]
  v_mul_f32_e64 v184, s44, v168
  v_mul_f32 v185, s44, v169
  v_mul_f32 v186, s44, v170
  v_mul_f32 v187, s44, v171
  v_mul_f32 v188, s44, v172
  v_mfma_f32_32x32x16_bf16 a[96:111], v[108:111], a[248:251], a[96:111]
  v_mul_f32_e64 v189, s44, v173
  v_mul_f32 v190, s44, v174
  v_mul_f32 v191, s44, v175
  v_exp_f32 v176, v176
  v_exp_f32 v177, v177
  v_mfma_f32_32x32x16_bf16 a[112:127], v[108:111], a[252:255], a[112:127]
  v_exp_f32 v178, v178
  v_exp_f32 v179, v179
  v_exp_f32 v180, v180
  v_exp_f32 v181, v181
  v_exp_f32 v182, v182
  s_waitcnt vmcnt(6)
  v_mfma_f32_32x32x16_bf16 a[96:111], v[112:115], a[0:3], a[96:111]
  v_exp_f32_e64 v183, v183
  v_exp_f32 v184, v184
  v_exp_f32 v185, v185
  v_exp_f32 v186, v186
  v_exp_f32 v187, v187
  v_mfma_f32_32x32x16_bf16 a[112:127], v[112:115], a[4:7], a[112:127]
  v_exp_f32_e64 v188, v188
  v_exp_f32 v189, v189
  v_exp_f32 v190, v190
  v_exp_f32 v191, v191
  v_add_f32 v176, 1.0, v176
  v_mfma_f32_32x32x16_bf16 a[96:111], v[116:119], a[8:11], a[96:111]
  v_add_f32_e64 v177, 1.0, v177
  v_add_f32 v178, 1.0, v178
  v_add_f32 v179, 1.0, v179
  v_add_f32 v180, 1.0, v180
  v_add_f32 v181, 1.0, v181
  v_mfma_f32_32x32x16_bf16 a[112:127], v[116:119], a[12:15], a[112:127]
  v_add_f32 v182, 1.0, v182
  v_add_f32 v183, 1.0, v183
  v_add_f32 v184, 1.0, v184
  v_add_f32 v185, 1.0, v185
  v_add_f32 v186, 1.0, v186
  s_waitcnt vmcnt(4)
  v_mfma_f32_32x32x16_bf16 a[96:111], v[120:123], a[16:19], a[96:111]
  v_add_f32_e64 v187, 1.0, v187
  v_add_f32 v188, 1.0, v188
  v_add_f32 v189, 1.0, v189
  v_add_f32 v190, 1.0, v190
  v_add_f32 v191, 1.0, v191
  v_mfma_f32_32x32x16_bf16 a[112:127], v[120:123], a[20:23], a[112:127]
  v_rcp_f32_e64 v176, v176
  v_rcp_f32 v177, v177
  v_rcp_f32 v178, v178
  v_rcp_f32 v179, v179
  v_rcp_f32 v180, v180
  v_mfma_f32_32x32x16_bf16 a[96:111], v[124:127], a[24:27], a[96:111]
  v_rcp_f32_e64 v181, v181
  v_rcp_f32 v182, v182
  v_rcp_f32 v183, v183
  v_rcp_f32 v184, v184
  v_rcp_f32 v185, v185
  v_mfma_f32_32x32x16_bf16 a[112:127], v[124:127], a[28:31], a[112:127]
  v_rcp_f32 v186, v186
  v_rcp_f32 v187, v187
  v_rcp_f32 v188, v188
  v_rcp_f32 v189, v189
  v_rcp_f32 v190, v190
  s_waitcnt vmcnt(2)
  v_mfma_f32_32x32x16_bf16 a[96:111], v[48:51], a[32:35], a[96:111]
  v_rcp_f32_e64 v191, v191
  v_mul_f32 v160, v160, v176
  v_mul_f32 v161, v161, v177
  v_mul_f32 v162, v162, v178
  v_mul_f32 v163, v163, v179
  v_mfma_f32_32x32x16_bf16 a[112:127], v[48:51], a[36:39], a[112:127]
  v_mul_f32_e64 v164, v164, v180
  v_mul_f32 v165, v165, v181
  v_mul_f32 v166, v166, v182
  v_mul_f32 v167, v167, v183
  v_mul_f32 v168, v168, v184
  v_mfma_f32_32x32x16_bf16 a[96:111], v[52:55], a[40:43], a[96:111]
  v_mul_f32_e64 v169, v169, v185
  v_mul_f32 v170, v170, v186
  v_mul_f32 v171, v171, v187
  v_mul_f32 v172, v172, v188
  v_mul_f32 v173, v173, v189
  v_mfma_f32_32x32x16_bf16 a[112:127], v[52:55], a[44:47], a[112:127]
  v_mul_f32 v174, v174, v190
  v_mul_f32 v175, v175, v191
  v_fmac_f32 v16, v128, v160
  v_fmac_f32 v17, v130, v161
  v_fmac_f32 v18, v132, v162
  s_waitcnt vmcnt(0)
  v_mfma_f32_32x32x16_bf16 a[112:127], v[56:59], a[52:55], a[112:127]
  v_fmac_f32_e64 v19, v134, v163
  v_fmac_f32 v20, v136, v164
  v_fmac_f32 v21, v138, v165
  v_fmac_f32 v22, v140, v166
  v_fmac_f32 v23, v142, v167
  v_mfma_f32_32x32x16_bf16 a[112:127], v[60:63], a[60:63], a[112:127]
  v_fmac_f32_e64 v24, v144, v168
  v_fmac_f32 v25, v146, v169
  v_fmac_f32 v26, v148, v170
  v_fmac_f32 v27, v150, v171
  v_fmac_f32 v28, v152, v172
  v_mfma_f32_32x32x16_bf16 a[96:111], v[56:59], a[48:51], a[96:111]
  v_fmac_f32_e64 v29, v154, v173
  v_fmac_f32 v30, v156, v174
  v_fmac_f32 v31, v158, v175
  v_mfma_f32_32x32x16_bf16 a[96:111], v[60:63], a[56:59], a[96:111]
  s_nop 1
  ds_write_b128 v5, a[112:115] offset:0
  ds_write_b128 v5, a[116:119] offset:1024
  ds_write_b128 v5, a[120:123] offset:2048
  ds_write_b128 v5, a[124:127] offset:3072
  s_nop 5
  v_accvgpr_read_b32 v48, a96
  v_accvgpr_read_b32 v49, a97
  v_accvgpr_read_b32 v50, a98
  v_accvgpr_read_b32 v51, a99
  v_accvgpr_read_b32 v52, a100
  v_accvgpr_read_b32 v53, a101
  v_accvgpr_read_b32 v54, a102
  v_accvgpr_read_b32 v55, a103
  v_accvgpr_read_b32 v56, a104
  v_accvgpr_read_b32 v57, a105
  v_accvgpr_read_b32 v58, a106
  v_accvgpr_read_b32 v59, a107
  v_accvgpr_read_b32 v60, a108
  v_accvgpr_read_b32 v61, a109
  v_accvgpr_read_b32 v62, a110
  v_accvgpr_read_b32 v63, a111
  s_waitcnt lgkmcnt(0)
  s_barrier
  ds_read_b128 v[80:83], v14 offset:0
  ds_read_b128 v[84:87], v14 offset:1024
  ds_read_b128 v[88:91], v14 offset:2048
  ds_read_b128 v[92:95], v14 offset:3072
  s_waitcnt lgkmcnt(3)
  s_nop 0
  v_pk_add_f32 v[48:49], v[48:49], v[80:81]
  v_pk_fma_f32 v[16:17], v[48:49], v[160:161], v[16:17]
  buffer_store_dword v16, v40, s[72:75], 0 offen offset:0 sc1
  buffer_store_dword v17, v40, s[72:75], 0 offen offset:1792 sc1
  v_add_u32 v40, 3584, v40
  v_pk_add_f32 v[50:51], v[50:51], v[82:83]
  v_pk_fma_f32 v[18:19], v[50:51], v[162:163], v[18:19]
  buffer_store_dword v18, v40, s[72:75], 0 offen offset:0 sc1
  buffer_store_dword v19, v40, s[72:75], 0 offen offset:1792 sc1
  v_add_u32 v40, 3584, v40
  s_waitcnt lgkmcnt(2)
  s_nop 0
  v_pk_add_f32 v[52:53], v[52:53], v[84:85]
  v_pk_fma_f32 v[20:21], v[52:53], v[164:165], v[20:21]
  buffer_store_dword v20, v40, s[72:75], 0 offen offset:0 sc1
  buffer_store_dword v21, v40, s[72:75], 0 offen offset:1792 sc1
  v_add_u32 v40, 3584, v40
  v_pk_add_f32 v[54:55], v[54:55], v[86:87]
  v_pk_fma_f32 v[22:23], v[54:55], v[166:167], v[22:23]
  buffer_store_dword v22, v40, s[72:75], 0 offen offset:0 sc1
  buffer_store_dword v23, v40, s[72:75], 0 offen offset:1792 sc1
  v_add_u32 v40, 3584, v40
  s_waitcnt lgkmcnt(1)
  s_nop 0
  v_pk_add_f32 v[56:57], v[56:57], v[88:89]
  v_pk_fma_f32 v[24:25], v[56:57], v[168:169], v[24:25]
  buffer_store_dword v24, v40, s[72:75], 0 offen offset:0 sc1
  buffer_store_dword v25, v40, s[72:75], 0 offen offset:1792 sc1
  v_add_u32 v40, 3584, v40
  v_pk_add_f32 v[58:59], v[58:59], v[90:91]
  v_pk_fma_f32 v[26:27], v[58:59], v[170:171], v[26:27]
  buffer_store_dword v26, v40, s[72:75], 0 offen offset:0 sc1
  buffer_store_dword v27, v40, s[72:75], 0 offen offset:1792 sc1
  v_add_u32 v40, 3584, v40
  s_waitcnt lgkmcnt(0)
  v_pk_add_f32 v[60:61], v[60:61], v[92:93]
  v_pk_fma_f32 v[28:29], v[60:61], v[172:173], v[28:29]
  buffer_store_dword v28, v40, s[72:75], 0 offen offset:0 sc1
  buffer_store_dword v29, v40, s[72:75], 0 offen offset:1792 sc1
  v_add_u32 v40, 3584, v40
  v_pk_add_f32 v[62:63], v[62:63], v[94:95]
  v_pk_fma_f32 v[30:31], v[62:63], v[174:175], v[30:31]
  buffer_store_dword v30, v40, s[72:75], 0 offen offset:0 sc1
  buffer_store_dword v31, v40, s[72:75], 0 offen offset:1792 sc1
L_end:
  s_endpgm
L_help:
  s_load_dwordx8 s[64:71], s[0:1], 24
  s_load_dwordx4 s[72:75], s[0:1], 80
  s_load_dwordx2 s[16:17], s[0:1], 96
  s_load_dwordx4 s[76:79], s[0:1], 112
  s_memrealtime s[58:59]
  v_lshrrev_b32_e64 v1, 6, v0
  v_and_b32 v0, 63, v0
  v_readfirstlane_b32 s3, v1
  s_lshl_b32 s4, s2, 2
  s_nop 1
  s_add_u32 s4, s4, s3
  v_lshrrev_b32 v2, 4, v0
  s_movk_i32 s5, 3584
  v_mul_u32_u24 v2, s5, v2
  v_and_b32 v3, 15, v0
  v_min_u32 v12, 13, v3
  v_lshl_add_u32 v2, v12, 7, v2
  v_min_u32_e64 v3, 48, v0
  v_lshlrev_b32 v3, 7, v3
  s_lshr_b32 s6, s4, 1
  s_mul_i32 s7, s6, 14336
  s_add_u32 s40, s7, 917504
  s_mul_i32 s41, s4, 6272
  s_add_u32 s42, s41, 802816
  s_mul_i32 s43, s6, 6272
  s_mov_b32 s10, 1605632
  s_mov_b32 s11, 0x20000
  s_mov_b32 s14, 401408
  s_mov_b32 s15, 0x20000
  s_mov_b32 s18, 1605632
  s_mov_b32 s19, 0x20000
  s_mov_b32 s30, 401408
  s_mov_b32 s31, 0x20000
  s_mov_b32 s26, 256
  s_mov_b32 s27, 0x20000
  s_mov_b32 s22, 11165696
  s_mov_b32 s23, 0x20000
  s_waitcnt lgkmcnt(0)
  s_and_b32 s5, s4, 1
  s_cmp_eq_u32 s5, 0
  s_cselect_b32 s8, s72, s74
  s_cselect_b32 s9, s73, s75
  s_cselect_b32 s12, s68, s70
  s_cselect_b32 s13, s69, s71
  s_cselect_b32 s28, s64, s66
  s_cselect_b32 s29, s65, s67
  s_mov_b32 s24, s76
  s_mov_b32 s25, s77
  s_mov_b32 s20, s78
  s_mov_b32 s21, s79
  buffer_load_dword v4, v2, s[8:11], s7 offen
  s_cmp_eq_u32 s4, 0
  s_cbranch_scc0 L_nn
  v_lshlrev_b32 v13, 7, v0
  v_mov_b32_e64 v15, 0
  s_mov_b32 s50, 11141120
  s_mov_b32 s51, 11149312
  s_mov_b32 s52, 11157504
  buffer_store_dword v15, v13, s[20:23], s50 offen sc1
  buffer_store_dword v15, v13, s[20:23], s51 offen sc1
  buffer_store_dword v15, v13, s[20:23], s52 offen sc1
  s_waitcnt vmcnt(0)
  s_or_b32 s58, s58, 1
  v_mov_b32 v13, s58
  s_mov_b64 exec, 1
  buffer_store_dword v13, off, s[24:27], 0 sc1
  s_mov_b64 exec, -1
L_nn:
  buffer_load_dword v6, v3, s[16:19], s41 offen
  buffer_load_dword v5, v2, s[8:11], s40 offen
  buffer_load_dword v14, v3, s[28:31], s43 offen
  buffer_load_dword v7, v2, s[8:11], s7 offen offset:1792
  buffer_load_dword v10, v3, s[16:19], s42 offen
  buffer_load_dword v8, v2, s[8:11], s40 offen offset:1792
  buffer_load_dword v9, v3, s[12:15], s43 offen
  s_waitcnt vmcnt(0)
  s_endpgm
L_nonce_spin:
  s_sleep 1
  buffer_load_dword v227, off, s[24:27], 0 sc1
  s_waitcnt vmcnt(0)
  v_readfirstlane_b32 s58, v227
  s_nop 3
  s_cmp_eq_u32 s58, 0
  s_cbranch_scc0 L_nonce_ok
  s_branch L_nonce_spin
L_E_spin:
  s_sleep 1
  buffer_load_dwordx3 v[232:234], v240, s[76:79], 0 offen sc1
  buffer_load_dwordx3 v[236:238], v241, s[76:79], 0 offen sc1
  s_waitcnt vmcnt(0)
  v_xor_b32_e64 v234, s58, v234
  v_xor_b32 v238, s58, v238
  v_ashrrev_i32 v235, 31, v240
  v_bfi_b32 v234, v235, 0, v234
  v_ashrrev_i32_e64 v235, 31, v241
  v_bfi_b32 v238, v235, 0, v238
  v_or_b32 v234, v234, v238
  v_cmp_ne_u32 vcc, 0, v234
  s_nop 4
  s_cbranch_vccz L_E_ok
  s_branch L_E_spin
L_f0_spin:
  s_sleep 1
  s_load_dword s100, s[20:21], s4 glc
  s_load_dword s101, s[20:21], s30 glc
  s_waitcnt lgkmcnt(0)
  s_add_u32 s100, s100, s101
  s_cmp_eq_u32 s100, 28
  s_cbranch_scc1 L_f0_ok
  s_branch L_f0_spin
L_f1_spin:
  s_sleep 1
  s_load_dword s100, s[20:21], s4 glc
  s_load_dword s101, s[20:21], s30 glc
  s_waitcnt lgkmcnt(0)
  s_add_u32 s100, s100, s101
  s_cmp_eq_u32 s100, 28
  s_cbranch_scc1 L_f1_ok
  s_branch L_f1_spin
L_f2_spin:
  s_sleep 1
  s_load_dword s100, s[20:21], s4 glc
  s_load_dword s101, s[20:21], s30 glc
  s_waitcnt lgkmcnt(0)
  s_add_u32 s100, s100, s101
  s_cmp_eq_u32 s100, 28
  s_cbranch_scc1 L_f2_ok
  s_branch L_f2_spin
L_last:
  s_endpgm
.section .rodata,"a"
.p2align 6
.amdhsa_kernel recurrent_scan__ssm_conv_s5__glu_gated_bilinear__prompt_kernel
  .amdhsa_next_free_vgpr 512
  .amdhsa_next_free_sgpr 102
  .amdhsa_accum_offset 256
  .amdhsa_group_segment_fixed_size 0
  .amdhsa_kernarg_size 128
  .amdhsa_user_sgpr_count 2
  .amdhsa_user_sgpr_kernarg_segment_ptr 1
  .amdhsa_system_sgpr_workgroup_id_x 1
  .amdhsa_float_denorm_mode_32 3
.end_amdhsa_kernel
```
